```python
import torch

def _softmax(x, axis=-1):
    return torch.softmax(x, dim=axis)
def _gelu(x):
    return torch.nn.functional.gelu(x, approximate="tanh")
def _silu(x):
    return torch.nn.functional.silu(x)
def _sigmoid(x):
    return torch.sigmoid(x)
def _layernorm(x, axis=-1, eps=1e-5):
    m = x.mean(dim=axis, keepdim=True)
    v = x.var(dim=axis, keepdim=True, unbiased=False)
    return (x - m) / torch.sqrt(v + eps)
def _scatter_add(tgt, idx, src, axis=0):
    return tgt.clone().index_add_(axis, idx, src)
def _segment_sum(src, seg, n):
    out = torch.zeros((n,) + src.shape[1:], dtype=src.dtype)
    return out.index_add_(0, seg, src)
def _pad(x, pw):
    flat = tuple(v for pair in reversed(pw) for v in pair)
    return torch.nn.functional.pad(x, flat)

kernel_name = 'interleave_layers__ssm_conv_h3__dense_activation_mish__prompt'

def setup_inputs():

    _w = (lambda a: (lambda t: t.to(torch.bfloat16) if t.is_floating_point() else t)(torch.as_tensor(a)))
    def _A_setup():
        B, S, D = 1, 2048, 512
        ks = 4
        return {
            "q": _w((lambda *s: torch.randn(*s, dtype=torch.bfloat16) * 0.05)(B, S, D)),
            "k": _w((lambda *s: torch.randn(*s, dtype=torch.bfloat16) * 0.2)(B, S, D)),
            "v": _w((lambda *s: torch.randn(*s, dtype=torch.bfloat16) * 0.2)(B, S, D)),
            "shift_k": _w((lambda *s: torch.randn(*s, dtype=torch.bfloat16) * 0.2)(D, ks) * 0.5),
            "ssm_k": _w((lambda *s: torch.randn(*s, dtype=torch.bfloat16) * 0.4)(D, S) * (1.0 / S ** 0.5)),
            "ssm_D": _w((lambda *s: torch.randn(*s, dtype=torch.bfloat16) * 0.2)(D)),
        }
    _A_in = _A_setup()

    def _B_setup():
        B, S, D, F = 1, 2048, 512, 1792
        return {
            "x": _w((lambda *s: torch.randn(*s, dtype=torch.bfloat16) * 0.05)(B, S, D)),
            "w1": _w((lambda *s: torch.randn(*s, dtype=torch.bfloat16) * 0.4)(D, F) * (D ** -0.5)),
            "b1": _w((lambda *s: torch.randn(*s, dtype=torch.bfloat16) * 0.1)(F)),
            "w2": _w((lambda *s: torch.randn(*s, dtype=torch.bfloat16) * 0.1)(F, D) * (F ** -0.5)),
        }
    _B_in = _B_setup()

    return {
        "A_q": _A_in["q"],
        "A_k": _A_in["k"],
        "A_v": _A_in["v"],
        "A_shift_k": _A_in["shift_k"],
        "A_ssm_k": _A_in["ssm_k"],
        "A_ssm_D": _A_in["ssm_D"],
        "B_x": _B_in["x"],
        "B_w1": _B_in["w1"],
        "B_b1": _B_in["b1"],
        "B_w2": _B_in["w2"],
    }

def reference(A_q, A_k, A_v, A_shift_k, A_ssm_k, A_ssm_D, B_x, B_w1, B_b1, B_w2):
    def _A_ref(q, k, v, shift_k, ssm_k, ssm_D):
        B, S, D = q.shape
        ks = shift_k.shape[-1]
        k_pad = _pad(k, ((0, 0), (ks - 1, 0), (0, 0)))
        k_shift = torch.zeros_like(k)
        for t in range(ks):
            k_shift = k_shift + k_pad[:, t:t + S, :] * shift_k[:, ks - 1 - t][None, None, :]
        kv = k_shift * v
        L = 2 * S
        kv_pad = _pad(kv, ((0, 0), (0, S), (0, 0)))
        kf_pad = _pad(ssm_k, ((0, 0), (0, S)))
        kv_f = (lambda x, axes=(-2,-1): torch.fft.rfft2(x.float(), dim=axes))(kv_pad[:, None, :, :], axes=(1, 2))
        kf_f = (lambda x, axes=(-2,-1): torch.fft.rfft2(x.float(), dim=axes))(kf_pad[:, None, :], axes=(1, 2))
        kf_f = (lambda x, *d: x.permute(*d))(kf_f, 1, 2, 0)
        y_f = kv_f * kf_f[None, :, :, :]
        y = (lambda x, s, axes=(-2,-1): torch.fft.irfft2(x, s=s, dim=axes).to(torch.bfloat16))(y_f, (1, L), axes=(1, 2))[:, 0, :S, :]
        y = y + kv * ssm_D[None, None, :]
        return q * y

    def _B_ref(x, w1, b1, w2):
        h = torch.einsum("bsd,df->bsf", x, w1) + b1
        sp = torch.log1p(torch.exp(-torch.abs(h))) + torch.where(h > 0, h, torch.zeros_like(h))
        act = h * torch.tanh(sp)
        return torch.einsum("bsf,fd->bsd", act, w2)

    x = A_q
    x = x + _A_ref(_layernorm(x, axis=-1), A_k, A_v, A_shift_k, A_ssm_k, A_ssm_D)
    x = x + _B_ref(_layernorm(x, axis=-1), B_w1, B_b1, B_w2)
    x = x + _A_ref(_layernorm(x, axis=-1), A_k, A_v, A_shift_k, A_ssm_k, A_ssm_D)
    x = x + _B_ref(_layernorm(x, axis=-1), B_w1, B_b1, B_w2)
    return x
```

```asm
; @launch grid=(256,1,1) block=(256,1,1) lds=163840
.amdgcn_target "amdgcn-amd-amdhsa--gfx950"
.text
.globl interleave_layers__ssm_conv_h3__dense_activation_mish__prompt_kernel
.p2align 8
.type interleave_layers__ssm_conv_h3__dense_activation_mish__prompt_kernel,@function
interleave_layers__ssm_conv_h3__dense_activation_mish__prompt_kernel:
    s_cmp_ge_u32 s2, 256
    s_cbranch_scc1 L_end
    s_load_dwordx16 s[64:79], s[0:1], 0
    s_load_dwordx8 s[80:87], s[0:1], 64
    s_load_dwordx2 s[88:89], s[0:1], 96
    v_lshrrev_b32 v5, 6, v0
    v_and_b32 v0, 63, v0
    v_readfirstlane_b32 s3, v5
    v_lshlrev_b32 v1, 4, v0
    v_lshlrev_b32 v2, 3, v0
    v_and_b32 v3, 15, v0
    v_lshrrev_b32 v4, 4, v0
    s_and_b32 s4, s2, 7
    s_lshr_b32 s5, s2, 3
    s_getreg_b32 s52, hwreg(HW_REG_XCC_ID, 0, 4)
    s_lshr_b32 s60, s5, 4
    s_lshl_b32 s53, s4, 1
    s_add_u32 s53, s53, s60
    s_and_b32 s54, s5, 15
    s_lshr_b32 s60, s5, 3
    s_lshl_b32 s55, s4, 2
    s_add_u32 s55, s55, s60
    s_and_b32 s56, s5, 7
    s_lshr_b32 s59, s54, 3
    s_mov_b32 s57, 0
    s_mov_b32 s7, 0
    s_mov_b32 s58, 30000
    s_waitcnt lgkmcnt(0)
    s_mov_b32 s8, s88
    s_and_b32 s9, s89, 0xffff
    s_mov_b32 s10, 24510464
    s_mov_b32 s11, 0x00020000
    s_mov_b32 s16, s66
    s_and_b32 s17, s67, 0xffff
    s_mov_b32 s18, 2097152
    s_mov_b32 s19, 0x00020000
    s_mov_b32 s20, s68
    s_and_b32 s21, s69, 0xffff
    s_mov_b32 s22, 2097152
    s_mov_b32 s23, 0x00020000
    s_mov_b32 s40, s70
    s_and_b32 s41, s71, 0xffff
    s_mov_b32 s42, 4096
    s_mov_b32 s43, 0x00020000
    s_mov_b32 s12, s64
    s_and_b32 s13, s65, 0xffff
    s_mov_b32 s14, 2097152
    s_mov_b32 s15, 0x00020000
    s_mov_b32 s44, s74
    s_and_b32 s45, s75, 0xffff
    s_mov_b32 s46, 1024
    s_mov_b32 s47, 0x00020000
    s_mov_b32 s24, s72
    s_and_b32 s25, s73, 0xffff
    s_mov_b32 s26, 2097152
    s_mov_b32 s27, 0x00020000
    s_mov_b32 s28, s78
    s_and_b32 s29, s79, 0xffff
    s_mov_b32 s30, 1835008
    s_mov_b32 s31, 0x00020000
    s_mov_b32 s32, s82
    s_and_b32 s33, s83, 0xffff
    s_mov_b32 s34, 1835008
    s_mov_b32 s35, 0x00020000
    s_mov_b32 s48, s80
    s_and_b32 s49, s81, 0xffff
    s_mov_b32 s50, 3584
    s_mov_b32 s51, 0x00020000
    s_mov_b32 s36, s84
    s_and_b32 s37, s85, 0xffff
    s_mov_b32 s38, 2097152
    s_mov_b32 s39, 0x00020000
    s_lshl_b32 s64, s4, 5
    s_add_u32 s64, s64, s5
    buffer_load_dword v208, off, s[8:11], 0 sc1
    v_and_b32 v5, 7, v0
    v_lshrrev_b32 v6, 3, v0
    s_lshl_b32 s60, s5, 16
    s_lshl_b32 s61, s4, 7
    s_add_u32 s60, s60, s61
    s_lshl_b32 s61, s3, 5
    s_add_u32 s60, s60, s61
    v_lshlrev_b32 v7, 13, v6
    v_lshl_add_u32 v7, v5, 2, v7
    v_add_u32 v7, s60, v7
    v_subrev_u32 v8, 3072, v7
    s_movk_i32 s60, 4096
    buffer_load_dword v176, v7, s[16:19], 0 offen offset:0
    buffer_load_dword v177, v7, s[16:19], 0 offen offset:1024
    buffer_load_dword v178, v7, s[16:19], 0 offen offset:2048
    buffer_load_dword v179, v7, s[16:19], 0 offen offset:3072
    buffer_load_dword v180, v7, s[16:19], s60 offen offset:0
    buffer_load_dword v181, v7, s[16:19], s60 offen offset:1024
    buffer_load_dword v182, v7, s[16:19], s60 offen offset:2048
    buffer_load_dword v183, v7, s[16:19], s60 offen offset:3072
    v_mov_b32 v184, 0
    v_mov_b32 v185, 0
    v_mov_b32 v186, 0
    v_cmpx_le_u32 vcc, 0x2000, v7
    s_nop 4
    buffer_load_dword v184, v8, s[16:19], 0 offen offset:0
    buffer_load_dword v185, v8, s[16:19], 0 offen offset:1024
    buffer_load_dword v186, v8, s[16:19], 0 offen offset:2048
    s_mov_b64 exec, -1
    buffer_load_dword v188, v7, s[20:23], 0 offen offset:0
    buffer_load_dword v189, v7, s[20:23], 0 offen offset:1024
    buffer_load_dword v190, v7, s[20:23], 0 offen offset:2048
    buffer_load_dword v191, v7, s[20:23], 0 offen offset:3072
    buffer_load_dword v192, v7, s[20:23], s60 offen offset:0
    buffer_load_dword v193, v7, s[20:23], s60 offen offset:1024
    buffer_load_dword v194, v7, s[20:23], s60 offen offset:2048
    buffer_load_dword v195, v7, s[20:23], s60 offen offset:3072
    v_lshlrev_b32 v9, 4, v5
    s_lshl_b32 s61, s4, 9
    s_lshl_b32 s62, s3, 7
    s_add_u32 s61, s61, s62
    buffer_load_dwordx4 v[196:199], v9, s[40:43], s61 offen
    v_lshlrev_b32 v10, 10, v3
    v_lshl_add_u32 v10, v4, 3, v10
    s_lshl_b32 s61, s55, 16
    s_lshl_b32 s62, s3, 14
    s_add_u32 s61, s61, s62
    s_lshl_b32 s62, s56, 7
    s_add_u32 s65, s61, s62
    buffer_load_dwordx2 v[200:201], v10, s[12:15], s65 offen offset:0
    buffer_load_dwordx2 v[202:203], v10, s[12:15], s65 offen offset:32
    buffer_load_dwordx2 v[204:205], v10, s[12:15], s65 offen offset:64
    buffer_load_dwordx2 v[206:207], v10, s[12:15], s65 offen offset:96
    s_lshl_b32 s61, s64, 2
    buffer_load_dword v209, off, s[44:47], s61
    s_lshr_b32 s61, s3, 1
    s_lshl_b32 s62, s64, 1
    s_add_u32 s61, s61, s62
    s_lshl_b32 s66, s61, 12
    s_and_b32 s67, s3, 1
    s_lshl_b32 s62, s67, 11
    s_add_u32 s62, s62, s66
    buffer_load_dwordx4 v[16:19], v1, s[24:27], s62 offen
    buffer_load_dword v20, v1, s[24:27], s62 offen offset:16
    buffer_load_dwordx4 v[24:27], v1, s[24:27], s62 offen offset:1024
    buffer_load_dword v28, v1, s[24:27], s62 offen offset:1040
    v_add_u32 v13, 0, v0
    v_mul_u32_u24 v14, 4682, v13
    v_lshrrev_b32 v14, 16, v14
    v_mul_u32_u24 v15, 14, v14
    v_sub_u32 v13, v13, v15
    v_mul_u32_u24 v14, 3584, v14
    v_lshl_add_u32 v244, v13, 4, v14
    v_add_u32 v13, 64, v0
    v_mul_u32_u24 v14, 4682, v13
    v_lshrrev_b32 v14, 16, v14
    v_mul_u32_u24 v15, 14, v14
    v_sub_u32 v13, v13, v15
    v_mul_u32_u24 v14, 3584, v14
    v_lshl_add_u32 v245, v13, 4, v14
    v_add_u32 v13, 128, v0
    v_mul_u32_u24 v14, 4682, v13
    v_lshrrev_b32 v14, 16, v14
    v_mul_u32_u24 v15, 14, v14
    v_sub_u32 v13, v13, v15
    v_mul_u32_u24 v14, 3584, v14
    v_lshl_add_u32 v246, v13, 4, v14
    v_add_u32 v13, 192, v0
    v_mul_u32_u24 v14, 4682, v13
    v_lshrrev_b32 v14, 16, v14
    v_mul_u32_u24 v15, 14, v14
    v_sub_u32 v13, v13, v15
    v_mul_u32_u24 v14, 3584, v14
    v_lshl_add_u32 v247, v13, 4, v14
    v_add_u32 v13, 256, v0
    v_mul_u32_u24 v14, 4682, v13
    v_lshrrev_b32 v14, 16, v14
    v_mul_u32_u24 v15, 14, v14
    v_sub_u32 v13, v13, v15
    v_mul_u32_u24 v14, 3584, v14
    v_lshl_add_u32 v248, v13, 4, v14
    v_add_u32 v13, 320, v0
    v_mul_u32_u24 v14, 4682, v13
    v_lshrrev_b32 v14, 16, v14
    v_mul_u32_u24 v15, 14, v14
    v_sub_u32 v13, v13, v15
    v_mul_u32_u24 v14, 3584, v14
    v_lshl_add_u32 v249, v13, 4, v14
    v_add_u32 v13, 384, v0
    v_mul_u32_u24 v14, 4682, v13
    v_lshrrev_b32 v14, 16, v14
    v_mul_u32_u24 v15, 14, v14
    v_sub_u32 v13, v13, v15
    v_mul_u32_u24 v14, 3584, v14
    v_lshl_add_u32 v255, v13, 4, v14
    s_waitcnt vmcnt(4)
    v_lshlrev_b32 v210, 16, v196
    v_lshlrev_b32 v211, 16, v198
    v_and_b32 v212, 0xffff0000, v196
    v_and_b32 v213, 0xffff0000, v198
    v_lshlrev_b32 v214, 16, v197
    v_lshlrev_b32 v215, 16, v199
    v_and_b32 v216, 0xffff0000, v197
    v_and_b32 v217, 0xffff0000, v199
    v_lshlrev_b32 v218, 16, v184
    v_and_b32 v219, 0xffff0000, v184
    v_lshlrev_b32 v220, 16, v185
    v_and_b32 v221, 0xffff0000, v185
    v_lshlrev_b32 v222, 16, v186
    v_and_b32 v223, 0xffff0000, v186
    v_lshlrev_b32 v224, 16, v176
    v_and_b32 v225, 0xffff0000, v176
    v_lshlrev_b32 v226, 16, v177
    v_and_b32 v227, 0xffff0000, v177
    v_lshlrev_b32 v228, 16, v178
    v_and_b32 v229, 0xffff0000, v178
    v_lshlrev_b32 v230, 16, v179
    v_and_b32 v231, 0xffff0000, v179
    v_lshlrev_b32 v232, 16, v180
    v_and_b32 v233, 0xffff0000, v180
    v_lshlrev_b32 v234, 16, v181
    v_and_b32 v235, 0xffff0000, v181
    v_lshlrev_b32 v236, 16, v182
    v_and_b32 v237, 0xffff0000, v182
    v_lshlrev_b32 v238, 16, v183
    v_and_b32 v239, 0xffff0000, v183
    v_pk_mul_f32 v[176:177], v[224:225], v[210:211]
    v_pk_fma_f32 v[176:177], v[222:223], v[212:213], v[176:177]
    v_pk_fma_f32 v[176:177], v[220:221], v[214:215], v[176:177]
    v_pk_fma_f32 v[176:177], v[218:219], v[216:217], v[176:177]
    v_lshlrev_b32 v252, 16, v188
    v_and_b32 v253, 0xffff0000, v188
    v_pk_mul_f32 v[176:177], v[176:177], v[252:253]
    v_pk_mul_f32 v[178:179], v[226:227], v[210:211]
    v_pk_fma_f32 v[178:179], v[224:225], v[212:213], v[178:179]
    v_pk_fma_f32 v[178:179], v[222:223], v[214:215], v[178:179]
    v_pk_fma_f32 v[178:179], v[220:221], v[216:217], v[178:179]
    v_lshlrev_b32 v252, 16, v189
    v_and_b32 v253, 0xffff0000, v189
    v_pk_mul_f32 v[178:179], v[178:179], v[252:253]
    v_pk_mul_f32 v[180:181], v[228:229], v[210:211]
    v_pk_fma_f32 v[180:181], v[226:227], v[212:213], v[180:181]
    v_pk_fma_f32 v[180:181], v[224:225], v[214:215], v[180:181]
    v_pk_fma_f32 v[180:181], v[222:223], v[216:217], v[180:181]
    v_lshlrev_b32 v252, 16, v190
    v_and_b32 v253, 0xffff0000, v190
    v_pk_mul_f32 v[180:181], v[180:181], v[252:253]
    v_pk_mul_f32 v[182:183], v[230:231], v[210:211]
    v_pk_fma_f32 v[182:183], v[228:229], v[212:213], v[182:183]
    v_pk_fma_f32 v[182:183], v[226:227], v[214:215], v[182:183]
    v_pk_fma_f32 v[182:183], v[224:225], v[216:217], v[182:183]
    v_lshlrev_b32 v252, 16, v191
    v_and_b32 v253, 0xffff0000, v191
    v_pk_mul_f32 v[182:183], v[182:183], v[252:253]
    v_pk_mul_f32 v[184:185], v[232:233], v[210:211]
    v_pk_fma_f32 v[184:185], v[230:231], v[212:213], v[184:185]
    v_pk_fma_f32 v[184:185], v[228:229], v[214:215], v[184:185]
    v_pk_fma_f32 v[184:185], v[226:227], v[216:217], v[184:185]
    v_lshlrev_b32 v252, 16, v192
    v_and_b32 v253, 0xffff0000, v192
    v_pk_mul_f32 v[184:185], v[184:185], v[252:253]
    v_pk_mul_f32 v[186:187], v[234:235], v[210:211]
    v_pk_fma_f32 v[186:187], v[232:233], v[212:213], v[186:187]
    v_pk_fma_f32 v[186:187], v[230:231], v[214:215], v[186:187]
    v_pk_fma_f32 v[186:187], v[228:229], v[216:217], v[186:187]
    v_lshlrev_b32 v252, 16, v193
    v_and_b32 v253, 0xffff0000, v193
    v_pk_mul_f32 v[186:187], v[186:187], v[252:253]
    v_pk_mul_f32 v[240:241], v[236:237], v[210:211]
    v_pk_fma_f32 v[240:241], v[234:235], v[212:213], v[240:241]
    v_pk_fma_f32 v[240:241], v[232:233], v[214:215], v[240:241]
    v_pk_fma_f32 v[240:241], v[230:231], v[216:217], v[240:241]
    v_lshlrev_b32 v252, 16, v194
    v_and_b32 v253, 0xffff0000, v194
    v_pk_mul_f32 v[240:241], v[240:241], v[252:253]
    v_pk_mul_f32 v[242:243], v[238:239], v[210:211]
    v_pk_fma_f32 v[242:243], v[236:237], v[212:213], v[242:243]
    v_pk_fma_f32 v[242:243], v[234:235], v[214:215], v[242:243]
    v_pk_fma_f32 v[242:243], v[232:233], v[216:217], v[242:243]
    v_lshlrev_b32 v252, 16, v195
    v_and_b32 v253, 0xffff0000, v195
    v_pk_mul_f32 v[242:243], v[242:243], v[252:253]
    v_cvt_pk_bf16_f32 v220, v242, v240
    v_cvt_pk_bf16_f32 v224, v243, v241
    v_cvt_pk_bf16_f32 v221, v186, v184
    v_cvt_pk_bf16_f32 v225, v187, v185
    v_cvt_pk_bf16_f32 v222, v182, v180
    v_cvt_pk_bf16_f32 v226, v183, v181
    v_cvt_pk_bf16_f32 v223, v178, v176
    v_cvt_pk_bf16_f32 v227, v179, v177
    v_lshlrev_b32 v9, 13, v5
    v_lshl_add_u32 v9, v6, 4, v9
    s_lshl_b32 s61, s4, 18
    s_lshl_b32 s62, s3, 16
    s_add_u32 s61, s61, s62
    s_lshl_b32 s62, s5, 7
    s_add_u32 s61, s61, s62
    s_add_u32 s61, s61, 262144
    s_add_u32 s62, s61, 4096
    buffer_store_dwordx4 v[220:223], v9, s[8:11], s61 offen sc1
    buffer_store_dwordx4 v[224:227], v9, s[8:11], s62 offen sc1
    v_lshlrev_b32 v228, 16, v200
    v_and_b32 v229, 0xffff0000, v200
    v_lshlrev_b32 v230, 16, v201
    v_and_b32 v231, 0xffff0000, v201
    v_lshlrev_b32 v232, 16, v202
    v_and_b32 v233, 0xffff0000, v202
    v_lshlrev_b32 v234, 16, v203
    v_and_b32 v235, 0xffff0000, v203
    v_lshlrev_b32 v236, 16, v204
    v_and_b32 v237, 0xffff0000, v204
    v_lshlrev_b32 v238, 16, v205
    v_and_b32 v239, 0xffff0000, v205
    v_lshlrev_b32 v240, 16, v206
    v_and_b32 v241, 0xffff0000, v206
    v_lshlrev_b32 v242, 16, v207
    v_and_b32 v243, 0xffff0000, v207
    v_accvgpr_write_b32 a224, v228
    v_accvgpr_write_b32 a225, v229
    v_accvgpr_write_b32 a226, v230
    v_accvgpr_write_b32 a227, v231
    v_accvgpr_write_b32 a228, v232
    v_accvgpr_write_b32 a229, v233
    v_accvgpr_write_b32 a230, v234
    v_accvgpr_write_b32 a231, v235
    v_accvgpr_write_b32 a232, v236
    v_accvgpr_write_b32 a233, v237
    v_accvgpr_write_b32 a234, v238
    v_accvgpr_write_b32 a235, v239
    v_accvgpr_write_b32 a236, v240
    v_accvgpr_write_b32 a237, v241
    v_accvgpr_write_b32 a238, v242
    v_accvgpr_write_b32 a239, v243
    v_pk_add_f32 v[212:213], v[228:229], v[230:231]
    v_pk_mul_f32 v[214:215], v[228:229], v[228:229]
    v_pk_fma_f32 v[214:215], v[230:231], v[230:231], v[214:215]
    v_pk_add_f32 v[212:213], v[212:213], v[232:233]
    v_pk_fma_f32 v[214:215], v[232:233], v[232:233], v[214:215]
    v_pk_add_f32 v[212:213], v[212:213], v[234:235]
    v_pk_fma_f32 v[214:215], v[234:235], v[234:235], v[214:215]
    v_pk_add_f32 v[212:213], v[212:213], v[236:237]
    v_pk_fma_f32 v[214:215], v[236:237], v[236:237], v[214:215]
    v_pk_add_f32 v[212:213], v[212:213], v[238:239]
    v_pk_fma_f32 v[214:215], v[238:239], v[238:239], v[214:215]
    v_pk_add_f32 v[212:213], v[212:213], v[240:241]
    v_pk_fma_f32 v[214:215], v[240:241], v[240:241], v[214:215]
    v_pk_add_f32 v[212:213], v[212:213], v[242:243]
    v_pk_fma_f32 v[214:215], v[242:243], v[242:243], v[214:215]
    v_add_f32 v210, v212, v213
    v_add_f32 v211, v214, v215
    v_mov_b32 v212, v210
    v_mov_b32 v213, v211
    s_nop 0
    v_permlane16_swap_b32 v210, v212
    v_permlane16_swap_b32 v211, v213
    v_pk_add_f32 v[210:211], v[210:211], v[212:213]
    v_mov_b32 v212, v210
    v_mov_b32 v213, v211
    s_nop 0
    v_permlane32_swap_b32 v210, v212
    v_permlane32_swap_b32 v211, v213
    v_pk_add_f32 v[210:211], v[210:211], v[212:213]
    v_lshlrev_b32 v9, 3, v3
    s_lshl_b32 s61, s55, 12
    s_lshl_b32 s62, s56, 9
    s_add_u32 s61, s61, s62
    s_lshl_b32 s62, s3, 7
    s_add_u32 s61, s61, s62
    s_add_u32 s61, s61, 4456448
    buffer_store_dwordx2 v[210:211], v9, s[8:11], s61 offen sc1
    v_readfirstlane_b32 s6, v208
    s_and_b32 s6, s6, 0xfffffff0
    s_add_u32 s6, s6, 0x9e3779b0
    s_waitcnt vmcnt(0)
    s_barrier
    s_add_u32 s63, s6, s52
    s_mov_b32 s65, 4096
    s_cmp_eq_u32 s3, 0
    s_cbranch_scc0 L_nf_1
    s_lshl_b32 s60, s2, 7
    s_add_u32 s60, s60, s65
    v_mov_b32 v5, s63
    s_mov_b64 exec, 1
    buffer_store_dword v5, off, s[8:11], s60 sc1
    s_mov_b64 exec, -1
L_nf_1:
    s_cmp_eq_u32 s3, 0
    s_cbranch_scc1 L_w0_2
    s_lshl_b32 s61, s53, 3
    s_lshl_b32 s62, s59, 2
    s_add_u32 s62, s62, s61
    s_add_u32 s62, s62, s3
    s_lshl_b32 s62, s62, 14
    s_lshl_b32 s63, s56, 11
    s_add_u32 s62, s62, s63
    s_add_u32 s62, s62, 5242880
    v_lshlrev_b32 v14, 5, v0
    buffer_load_dword v250, v14, s[8:11], s62 offen
    s_lshl_b32 s62, s3, 1
    s_add_u32 s61, s61, s62
    s_lshl_b32 s61, s61, 4
    s_add_u32 s61, s61, s54
    s_mul_i32 s61, s61, 3584
    s_add_u32 s61, s61, 9437184
    s_add_u32 s62, s61, 57344
    v_mul_u32_u24 v14, 56, v0
    buffer_load_dword v251, v14, s[8:11], s61 offen
    buffer_load_dword v254, v14, s[8:11], s62 offen
L_w0_2:
    v_accvgpr_write_b32 a250, v209
    v_alignbyte_b32 v32, v17, v16, 2
    v_alignbyte_b32 v33, v18, v17, 2
    v_alignbyte_b32 v34, v19, v18, 2
    v_alignbyte_b32 v35, v20, v19, 2
    v_alignbyte_b32 v36, v25, v24, 2
    v_alignbyte_b32 v37, v26, v25, 2
    v_alignbyte_b32 v38, v27, v26, 2
    v_alignbyte_b32 v39, v28, v27, 2
    s_lshr_b32 s61, s3, 1
    s_mul_i32 s66, s61, 8320
    s_add_u32 s66, s66, 123904
    s_and_b32 s67, s3, 1
    s_lshl_b32 s62, s67, 11
    s_add_u32 s62, s62, s66
    s_add_u32 s62, s62, 32
    v_add_u32 v7, s62, v1
    ds_write_b128 v7, v[16:19]
    ds_write_b128 v7, v[24:27] offset:1024
    ds_write_b128 v7, v[32:35] offset:4160
    ds_write_b128 v7, v[36:39] offset:5184
    v_mov_b32 v8, 0
    v_mov_b32 v9, 0
    s_mul_i32 s61, s61, 4608
    s_add_u32 s61, s61, 114688
    v_add_u32 v7, s61, v2
    ds_write_b64 v7, v[8:9]
    s_cmp_eq_u32 s67, 0
    s_cbranch_scc0 L_pad_3
    v_readfirstlane_b32 s62, v16
    s_lshl_b32 s62, s62, 16
    s_nop 0
    v_mov_b32 v9, s62
    v_cmp_eq_u32 vcc, 7, v0
    s_nop 1
    v_cndmask_b32 v9, 0, v9, vcc
    v_lshlrev_b32 v7, 2, v0
    v_add_u32 v7, s66, v7
    s_mov_b64 exec, 0xff
    ds_write_b32 v7, v8
    ds_write_b32 v7, v9 offset:4160
    s_mov_b64 exec, -1
L_pad_3:
    v_lshrrev_b32 v11, 1, v4
    v_lshlrev_b32 v11, 4, v11
    v_and_b32 v12, 1, v4
    v_lshlrev_b32 v12, 3, v12
    v_sub_u32 v11, v11, v12
    v_add_u32 v11, v11, v3
    v_subrev_u32 v11, 7, v11
    v_and_b32 v12, 1, v11
    v_sub_u32 v13, v11, v12
    v_lshlrev_b32 v13, 1, v13
    v_mul_u32_u24 v12, 4160, v12
    v_add_u32 v13, v13, v12
    s_lshl_b32 s62, s67, 8
    s_add_u32 s62, s62, s66
    s_add_u32 s62, s62, 32
    v_add_u32 v13, s62, v13
    s_waitcnt lgkmcnt(0)
    s_barrier
    v_add_u32 v5, 0, v13
    ds_read2_b32 v[16:17], v5 offset0:0 offset1:1
    ds_read2_b32 v[18:19], v5 offset0:2 offset1:3
    ds_read2_b32 v[20:21], v5 offset0:16 offset1:17
    ds_read2_b32 v[22:23], v5 offset0:18 offset1:19
    ds_read2_b32 v[24:25], v5 offset0:32 offset1:33
    ds_read2_b32 v[26:27], v5 offset0:34 offset1:35
    ds_read2_b32 v[28:29], v5 offset0:48 offset1:49
    ds_read2_b32 v[30:31], v5 offset0:50 offset1:51
    s_waitcnt lgkmcnt(6)
    v_add_u32 v6, 512, v13
    ds_read2_b32 v[32:33], v6 offset0:0 offset1:1
    ds_read2_b32 v[34:35], v6 offset0:2 offset1:3
    ds_read2_b32 v[36:37], v6 offset0:16 offset1:17
    ds_read2_b32 v[38:39], v6 offset0:18 offset1:19
    ds_read2_b32 v[40:41], v6 offset0:32 offset1:33
    ds_read2_b32 v[42:43], v6 offset0:34 offset1:35
    ds_read2_b32 v[44:45], v6 offset0:48 offset1:49
    ds_read2_b32 v[46:47], v6 offset0:50 offset1:51
    s_waitcnt lgkmcnt(6)
    v_add_u32 v5, 1024, v13
    ds_read2_b32 v[48:49], v5 offset0:0 offset1:1
    ds_read2_b32 v[50:51], v5 offset0:2 offset1:3
    ds_read2_b32 v[52:53], v5 offset0:16 offset1:17
    ds_read2_b32 v[54:55], v5 offset0:18 offset1:19
    ds_read2_b32 v[56:57], v5 offset0:32 offset1:33
    ds_read2_b32 v[58:59], v5 offset0:34 offset1:35
    ds_read2_b32 v[60:61], v5 offset0:48 offset1:49
    ds_read2_b32 v[62:63], v5 offset0:50 offset1:51
    s_waitcnt lgkmcnt(6)
    v_add_u32 v6, 1536, v13
    ds_read2_b32 v[64:65], v6 offset0:0 offset1:1
    ds_read2_b32 v[66:67], v6 offset0:2 offset1:3
    ds_read2_b32 v[68:69], v6 offset0:16 offset1:17
    ds_read2_b32 v[70:71], v6 offset0:18 offset1:19
    ds_read2_b32 v[72:73], v6 offset0:32 offset1:33
    ds_read2_b32 v[74:75], v6 offset0:34 offset1:35
    ds_read2_b32 v[76:77], v6 offset0:48 offset1:49
    ds_read2_b32 v[78:79], v6 offset0:50 offset1:51
    s_waitcnt lgkmcnt(6)
    v_add_u32 v5, 2048, v13
    ds_read2_b32 v[80:81], v5 offset0:0 offset1:1
    ds_read2_b32 v[82:83], v5 offset0:2 offset1:3
    ds_read2_b32 v[84:85], v5 offset0:16 offset1:17
    ds_read2_b32 v[86:87], v5 offset0:18 offset1:19
    ds_read2_b32 v[88:89], v5 offset0:32 offset1:33
    ds_read2_b32 v[90:91], v5 offset0:34 offset1:35
    ds_read2_b32 v[92:93], v5 offset0:48 offset1:49
    ds_read2_b32 v[94:95], v5 offset0:50 offset1:51
    s_waitcnt lgkmcnt(6)
    v_add_u32 v6, 2560, v13
    ds_read2_b32 v[96:97], v6 offset0:0 offset1:1
    ds_read2_b32 v[98:99], v6 offset0:2 offset1:3
    ds_read2_b32 v[100:101], v6 offset0:16 offset1:17
    ds_read2_b32 v[102:103], v6 offset0:18 offset1:19
    ds_read2_b32 v[104:105], v6 offset0:32 offset1:33
    ds_read2_b32 v[106:107], v6 offset0:34 offset1:35
    ds_read2_b32 v[108:109], v6 offset0:48 offset1:49
    ds_read2_b32 v[110:111], v6 offset0:50 offset1:51
    s_waitcnt lgkmcnt(6)
    v_add_u32 v5, 3072, v13
    ds_read2_b32 v[112:113], v5 offset0:0 offset1:1
    ds_read2_b32 v[114:115], v5 offset0:2 offset1:3
    ds_read2_b32 v[116:117], v5 offset0:16 offset1:17
    ds_read2_b32 v[118:119], v5 offset0:18 offset1:19
    ds_read2_b32 v[120:121], v5 offset0:32 offset1:33
    ds_read2_b32 v[122:123], v5 offset0:34 offset1:35
    ds_read2_b32 v[124:125], v5 offset0:48 offset1:49
    ds_read2_b32 v[126:127], v5 offset0:50 offset1:51
    s_waitcnt lgkmcnt(6)
    v_add_u32 v6, 3584, v13
    ds_read2_b32 v[128:129], v6 offset0:0 offset1:1
    ds_read2_b32 v[130:131], v6 offset0:2 offset1:3
    ds_read2_b32 v[132:133], v6 offset0:16 offset1:17
    ds_read2_b32 v[134:135], v6 offset0:18 offset1:19
    ds_read2_b32 v[136:137], v6 offset0:32 offset1:33
    ds_read2_b32 v[138:139], v6 offset0:34 offset1:35
    ds_read2_b32 v[140:141], v6 offset0:48 offset1:49
    ds_read2_b32 v[142:143], v6 offset0:50 offset1:51
    s_waitcnt lgkmcnt(6)
    s_lshl_b32 s61, s4, 7
    s_add_u32 s61, s61, 4096
    s_cmp_eq_u32 s3, 0
    s_cbranch_scc0 L_skip_4
    v_lshlrev_b32 v5, 10, v0
    s_mov_b32 exec_lo, 0xffffffff
    s_mov_b32 exec_hi, 0
    s_mov_b32 s62, 0
L_poll_5:
    buffer_load_dword v6, v5, s[8:11], s61 offen sc1
    s_add_u32 s62, s62, 1
    s_cmp_gt_u32 s62, s58
    s_cbranch_scc1 L_to_7
    s_waitcnt vmcnt(0)
    v_subrev_u32 v7, s6, v6
    v_cmp_le_u32 vcc, 16, v7
    s_cmp_eq_u64 vcc, 0
    s_cbranch_scc0 L_poll_5
    s_branch L_ok_6
L_to_7:
    s_mov_b32 s58, 0
    s_waitcnt vmcnt(0)
L_ok_6:
    v_subrev_u32 v7, s6, v6
    v_cmp_ne_u32 vcc, s52, v7
    s_cmp_eq_u64 vcc, 0
    s_cselect_b32 s66, 1, 0
    s_mov_b64 exec, -1
    s_lshl_b32 s62, s64, 13
    s_add_u32 s62, s62, 262144
    s_mov_b32 m0, 115200
    s_add_u32 s63, s62, 0
    buffer_load_dwordx4 v1, s[8:11], s63 offen sc1 lds
    s_mov_b32 m0, 116224
    s_add_u32 s63, s62, 1024
    buffer_load_dwordx4 v1, s[8:11], s63 offen sc1 lds
    s_mov_b32 m0, 117248
    s_add_u32 s63, s62, 2048
    buffer_load_dwordx4 v1, s[8:11], s63 offen sc1 lds
    s_mov_b32 m0, 118272
    s_add_u32 s63, s62, 3072
    buffer_load_dwordx4 v1, s[8:11], s63 offen sc1 lds
    s_mov_b32 m0, 119808
    s_add_u32 s63, s62, 4096
    buffer_load_dwordx4 v1, s[8:11], s63 offen sc1 lds
    s_mov_b32 m0, 120832
    s_add_u32 s63, s62, 5120
    buffer_load_dwordx4 v1, s[8:11], s63 offen sc1 lds
    s_mov_b32 m0, 121856
    s_add_u32 s63, s62, 6144
    buffer_load_dwordx4 v1, s[8:11], s63 offen sc1 lds
    s_mov_b32 m0, 122880
    s_add_u32 s63, s62, 7168
    buffer_load_dwordx4 v1, s[8:11], s63 offen sc1 lds
    s_lshl_b32 s61, s53, 3
    s_lshl_b32 s62, s59, 2
    s_add_u32 s62, s62, s61
    s_add_u32 s62, s62, s3
    s_lshl_b32 s62, s62, 14
    s_lshl_b32 s63, s56, 11
    s_add_u32 s62, s62, s63
    s_add_u32 s62, s62, 5242880
    v_lshlrev_b32 v14, 5, v0
    buffer_load_dword v250, v14, s[8:11], s62 offen
    s_lshl_b32 s62, s3, 1
    s_add_u32 s61, s61, s62
    s_lshl_b32 s61, s61, 4
    s_add_u32 s61, s61, s54
    s_mul_i32 s61, s61, 3584
    s_add_u32 s61, s61, 9437184
    s_add_u32 s62, s61, 57344
    v_mul_u32_u24 v14, 56, v0
    buffer_load_dword v251, v14, s[8:11], s61 offen
    buffer_load_dword v254, v14, s[8:11], s62 offen
    s_mov_b32 s62, s66
    s_waitcnt vmcnt(3)
    v_mov_b32 v5, 156672
    v_mov_b32 v6, s62
    ds_write_b32 v5, v6
    s_waitcnt lgkmcnt(0)
L_skip_4:
    s_barrier
    v_mov_b32 v5, 156672
    ds_read_b32 v6, v5
    s_waitcnt lgkmcnt(0)
    v_readfirstlane_b32 s7, v6
    v_lshlrev_b32 v5, 5, v3
    v_lshrrev_b32 v7, 1, v4
    v_lshlrev_b32 v7, 5, v7
    v_sub_u32 v5, v5, v7
    v_and_b32 v7, 1, v4
    v_lshl_add_u32 v5, v7, 4, v5
    s_lshr_b32 s61, s3, 1
    s_mul_i32 s65, s61, 4608
    s_add_u32 s65, s65, 114688
    s_and_b32 s62, s3, 1
    s_lshl_b32 s62, s62, 8
    s_sub_u32 s62, s65, s62
    s_add_u32 s62, s62, 320
    v_add_u32 v5, s62, v5
    s_mul_i32 s70, s3, 458752
    s_mul_i32 s62, s54, 224
    s_add_u32 s70, s70, s62
    s_mul_i32 s71, s3, 28672
    ds_read_b128 v[144:147], v5 offset:192
    ds_read_b128 v[148:151], v5 offset:704
    ds_read_b128 v[152:155], v5 offset:1216
    ds_read_b128 v[156:159], v5 offset:1728
    ds_read_b128 v[160:163], v5 offset:2240
    ds_read_b128 v[164:167], v5 offset:2752
    ds_read_b128 v[168:171], v5 offset:3264
    ds_read_b128 v[172:175], v5 offset:3776
    s_waitcnt lgkmcnt(0)
    ds_read_b128 v[176:179], v5 offset:128
    ds_read_b128 v[180:183], v5 offset:640
    ds_read_b128 v[184:187], v5 offset:1152
    ds_read_b128 v[188:191], v5 offset:1664
    ds_read_b128 v[192:195], v5 offset:2176
    ds_read_b128 v[196:199], v5 offset:2688
    ds_read_b128 v[200:203], v5 offset:3200
    ds_read_b128 v[204:207], v5 offset:3712
    s_add_u32 m0, s71, 0
    s_add_u32 s68, s70, 0
    v_mfma_f32_16x16x32_bf16 v[208:211], v[16:19], v[144:147], 0
    buffer_load_dwordx4 v244, s[28:31], s68 offen lds
    v_mfma_f32_16x16x32_bf16 v[212:215], v[32:35], v[144:147], 0
    v_mfma_f32_16x16x32_bf16 v[216:219], v[48:51], v[144:147], 0
    v_mfma_f32_16x16x32_bf16 v[220:223], v[64:67], v[144:147], 0
    s_add_u32 m0, s71, 1024
    s_add_u32 s68, s70, 0
    v_mfma_f32_16x16x32_bf16 v[224:227], v[80:83], v[144:147], 0
    buffer_load_dwordx4 v245, s[28:31], s68 offen lds
    v_mfma_f32_16x16x32_bf16 v[228:231], v[96:99], v[144:147], 0
    v_mfma_f32_16x16x32_bf16 v[232:235], v[112:115], v[144:147], 0
    v_mfma_f32_16x16x32_bf16 v[236:239], v[128:131], v[144:147], 0
    s_add_u32 m0, s71, 2048
    s_add_u32 s68, s70, 0
    v_mfma_f32_16x16x32_bf16 v[212:215], v[16:19], v[148:151], v[212:215]
    buffer_load_dwordx4 v246, s[28:31], s68 offen lds
    v_mfma_f32_16x16x32_bf16 v[216:219], v[32:35], v[148:151], v[216:219]
    v_mfma_f32_16x16x32_bf16 v[220:223], v[48:51], v[148:151], v[220:223]
    v_mfma_f32_16x16x32_bf16 v[224:227], v[64:67], v[148:151], v[224:227]
    s_add_u32 m0, s71, 3072
    s_add_u32 s68, s70, 0
    v_mfma_f32_16x16x32_bf16 v[228:231], v[80:83], v[148:151], v[228:231]
    buffer_load_dwordx4 v247, s[28:31], s68 offen lds
    v_mfma_f32_16x16x32_bf16 v[232:235], v[96:99], v[148:151], v[232:235]
    v_mfma_f32_16x16x32_bf16 v[236:239], v[112:115], v[148:151], v[236:239]
    v_mfma_f32_16x16x32_bf16 v[216:219], v[16:19], v[152:155], v[216:219]
    s_add_u32 m0, s71, 4096
    s_add_u32 s68, s70, 0
    v_mfma_f32_16x16x32_bf16 v[220:223], v[32:35], v[152:155], v[220:223]
    buffer_load_dwordx4 v248, s[28:31], s68 offen lds
    v_mfma_f32_16x16x32_bf16 v[224:227], v[48:51], v[152:155], v[224:227]
    v_mfma_f32_16x16x32_bf16 v[228:231], v[64:67], v[152:155], v[228:231]
    v_mfma_f32_16x16x32_bf16 v[232:235], v[80:83], v[152:155], v[232:235]
    s_add_u32 m0, s71, 5120
    s_add_u32 s68, s70, 0
    v_mfma_f32_16x16x32_bf16 v[236:239], v[96:99], v[152:155], v[236:239]
    buffer_load_dwordx4 v249, s[28:31], s68 offen lds
    v_mfma_f32_16x16x32_bf16 v[220:223], v[16:19], v[156:159], v[220:223]
    v_mfma_f32_16x16x32_bf16 v[224:227], v[32:35], v[156:159], v[224:227]
    v_mfma_f32_16x16x32_bf16 v[228:231], v[48:51], v[156:159], v[228:231]
    s_add_u32 m0, s71, 6144
    s_add_u32 s68, s70, 0
    v_mfma_f32_16x16x32_bf16 v[232:235], v[64:67], v[156:159], v[232:235]
    buffer_load_dwordx4 v255, s[28:31], s68 offen lds
    v_mfma_f32_16x16x32_bf16 v[236:239], v[80:83], v[156:159], v[236:239]
    v_mfma_f32_16x16x32_bf16 v[224:227], v[16:19], v[160:163], v[224:227]
    v_mfma_f32_16x16x32_bf16 v[228:231], v[32:35], v[160:163], v[228:231]
    s_add_u32 m0, s71, 7168
    s_add_u32 s68, s70, 114688
    v_mfma_f32_16x16x32_bf16 v[232:235], v[48:51], v[160:163], v[232:235]
    buffer_load_dwordx4 v244, s[28:31], s68 offen lds
    v_mfma_f32_16x16x32_bf16 v[236:239], v[64:67], v[160:163], v[236:239]
    v_mfma_f32_16x16x32_bf16 v[228:231], v[16:19], v[164:167], v[228:231]
    v_mfma_f32_16x16x32_bf16 v[232:235], v[32:35], v[164:167], v[232:235]
    s_add_u32 m0, s71, 8192
    s_add_u32 s68, s70, 114688
    v_mfma_f32_16x16x32_bf16 v[236:239], v[48:51], v[164:167], v[236:239]
    buffer_load_dwordx4 v245, s[28:31], s68 offen lds
    v_mfma_f32_16x16x32_bf16 v[232:235], v[16:19], v[168:171], v[232:235]
    v_mfma_f32_16x16x32_bf16 v[236:239], v[32:35], v[168:171], v[236:239]
    v_mfma_f32_16x16x32_bf16 v[236:239], v[16:19], v[172:175], v[236:239]
    s_waitcnt lgkmcnt(0)
    ds_read_b128 v[144:147], v5 offset:64
    ds_read_b128 v[148:151], v5 offset:576
    ds_read_b128 v[152:155], v5 offset:1088
    ds_read_b128 v[156:159], v5 offset:1600
    ds_read_b128 v[160:163], v5 offset:2112
    ds_read_b128 v[164:167], v5 offset:2624
    ds_read_b128 v[168:171], v5 offset:3136
    ds_read_b128 v[172:175], v5 offset:3648
    s_add_u32 m0, s71, 9216
    s_add_u32 s68, s70, 114688
    v_mfma_f32_16x16x32_bf16 v[208:211], v[20:23], v[176:179], v[208:211]
    buffer_load_dwordx4 v246, s[28:31], s68 offen lds
    v_mfma_f32_16x16x32_bf16 v[212:215], v[36:39], v[176:179], v[212:215]
    v_mfma_f32_16x16x32_bf16 v[216:219], v[52:55], v[176:179], v[216:219]
    v_mfma_f32_16x16x32_bf16 v[220:223], v[68:71], v[176:179], v[220:223]
    s_add_u32 m0, s71, 10240
    s_add_u32 s68, s70, 114688
    v_mfma_f32_16x16x32_bf16 v[224:227], v[84:87], v[176:179], v[224:227]
    buffer_load_dwordx4 v247, s[28:31], s68 offen lds
    v_mfma_f32_16x16x32_bf16 v[228:231], v[100:103], v[176:179], v[228:231]
    v_mfma_f32_16x16x32_bf16 v[232:235], v[116:119], v[176:179], v[232:235]
    v_mfma_f32_16x16x32_bf16 v[236:239], v[132:135], v[176:179], v[236:239]
    s_add_u32 m0, s71, 11264
    s_add_u32 s68, s70, 114688
    v_mfma_f32_16x16x32_bf16 v[212:215], v[20:23], v[180:183], v[212:215]
    buffer_load_dwordx4 v248, s[28:31], s68 offen lds
    v_mfma_f32_16x16x32_bf16 v[216:219], v[36:39], v[180:183], v[216:219]
    v_mfma_f32_16x16x32_bf16 v[220:223], v[52:55], v[180:183], v[220:223]
    v_mfma_f32_16x16x32_bf16 v[224:227], v[68:71], v[180:183], v[224:227]
    s_add_u32 m0, s71, 12288
    s_add_u32 s68, s70, 114688
    v_mfma_f32_16x16x32_bf16 v[228:231], v[84:87], v[180:183], v[228:231]
    buffer_load_dwordx4 v249, s[28:31], s68 offen lds
    v_mfma_f32_16x16x32_bf16 v[232:235], v[100:103], v[180:183], v[232:235]
    v_mfma_f32_16x16x32_bf16 v[236:239], v[116:119], v[180:183], v[236:239]
    v_mfma_f32_16x16x32_bf16 v[216:219], v[20:23], v[184:187], v[216:219]
    s_add_u32 m0, s71, 13312
    s_add_u32 s68, s70, 114688
    v_mfma_f32_16x16x32_bf16 v[220:223], v[36:39], v[184:187], v[220:223]
    buffer_load_dwordx4 v255, s[28:31], s68 offen lds
    v_mfma_f32_16x16x32_bf16 v[224:227], v[52:55], v[184:187], v[224:227]
    v_mfma_f32_16x16x32_bf16 v[228:231], v[68:71], v[184:187], v[228:231]
    v_mfma_f32_16x16x32_bf16 v[232:235], v[84:87], v[184:187], v[232:235]
    s_add_u32 m0, s71, 14336
    s_add_u32 s68, s70, 229376
    v_mfma_f32_16x16x32_bf16 v[236:239], v[100:103], v[184:187], v[236:239]
    buffer_load_dwordx4 v244, s[28:31], s68 offen lds
    v_mfma_f32_16x16x32_bf16 v[220:223], v[20:23], v[188:191], v[220:223]
    v_mfma_f32_16x16x32_bf16 v[224:227], v[36:39], v[188:191], v[224:227]
    v_mfma_f32_16x16x32_bf16 v[228:231], v[52:55], v[188:191], v[228:231]
    s_add_u32 m0, s71, 15360
    s_add_u32 s68, s70, 229376
    v_mfma_f32_16x16x32_bf16 v[232:235], v[68:71], v[188:191], v[232:235]
    buffer_load_dwordx4 v245, s[28:31], s68 offen lds
    v_mfma_f32_16x16x32_bf16 v[236:239], v[84:87], v[188:191], v[236:239]
    v_mfma_f32_16x16x32_bf16 v[224:227], v[20:23], v[192:195], v[224:227]
    v_mfma_f32_16x16x32_bf16 v[228:231], v[36:39], v[192:195], v[228:231]
    s_add_u32 m0, s71, 16384
    s_add_u32 s68, s70, 229376
    v_mfma_f32_16x16x32_bf16 v[232:235], v[52:55], v[192:195], v[232:235]
    buffer_load_dwordx4 v246, s[28:31], s68 offen lds
    v_mfma_f32_16x16x32_bf16 v[236:239], v[68:71], v[192:195], v[236:239]
    v_mfma_f32_16x16x32_bf16 v[228:231], v[20:23], v[196:199], v[228:231]
    v_mfma_f32_16x16x32_bf16 v[232:235], v[36:39], v[196:199], v[232:235]
    s_add_u32 m0, s71, 17408
    s_add_u32 s68, s70, 229376
    v_mfma_f32_16x16x32_bf16 v[236:239], v[52:55], v[196:199], v[236:239]
    buffer_load_dwordx4 v247, s[28:31], s68 offen lds
    v_mfma_f32_16x16x32_bf16 v[232:235], v[20:23], v[200:203], v[232:235]
    v_mfma_f32_16x16x32_bf16 v[236:239], v[36:39], v[200:203], v[236:239]
    v_mfma_f32_16x16x32_bf16 v[236:239], v[20:23], v[204:207], v[236:239]
    s_waitcnt lgkmcnt(0)
    ds_read_b128 v[176:179], v5 offset:0
    ds_read_b128 v[180:183], v5 offset:512
    ds_read_b128 v[184:187], v5 offset:1024
    ds_read_b128 v[188:191], v5 offset:1536
    ds_read_b128 v[192:195], v5 offset:2048
    ds_read_b128 v[196:199], v5 offset:2560
    ds_read_b128 v[200:203], v5 offset:3072
    ds_read_b128 v[204:207], v5 offset:3584
    s_add_u32 m0, s71, 18432
    s_add_u32 s68, s70, 229376
    v_mfma_f32_16x16x32_bf16 v[208:211], v[24:27], v[144:147], v[208:211]
    buffer_load_dwordx4 v248, s[28:31], s68 offen lds
    v_mfma_f32_16x16x32_bf16 v[212:215], v[40:43], v[144:147], v[212:215]
    v_mfma_f32_16x16x32_bf16 v[216:219], v[56:59], v[144:147], v[216:219]
    v_mfma_f32_16x16x32_bf16 v[220:223], v[72:75], v[144:147], v[220:223]
    s_add_u32 m0, s71, 19456
    s_add_u32 s68, s70, 229376
    v_mfma_f32_16x16x32_bf16 v[224:227], v[88:91], v[144:147], v[224:227]
    buffer_load_dwordx4 v249, s[28:31], s68 offen lds
    v_mfma_f32_16x16x32_bf16 v[228:231], v[104:107], v[144:147], v[228:231]
    v_mfma_f32_16x16x32_bf16 v[232:235], v[120:123], v[144:147], v[232:235]
    v_mfma_f32_16x16x32_bf16 v[236:239], v[136:139], v[144:147], v[236:239]
    s_add_u32 m0, s71, 20480
    s_add_u32 s68, s70, 229376
    v_mfma_f32_16x16x32_bf16 v[212:215], v[24:27], v[148:151], v[212:215]
    buffer_load_dwordx4 v255, s[28:31], s68 offen lds
    v_mfma_f32_16x16x32_bf16 v[216:219], v[40:43], v[148:151], v[216:219]
    v_mfma_f32_16x16x32_bf16 v[220:223], v[56:59], v[148:151], v[220:223]
    v_mfma_f32_16x16x32_bf16 v[224:227], v[72:75], v[148:151], v[224:227]
    s_add_u32 m0, s71, 21504
    s_add_u32 s68, s70, 344064
    v_mfma_f32_16x16x32_bf16 v[228:231], v[88:91], v[148:151], v[228:231]
    buffer_load_dwordx4 v244, s[28:31], s68 offen lds
    v_mfma_f32_16x16x32_bf16 v[232:235], v[104:107], v[148:151], v[232:235]
    v_mfma_f32_16x16x32_bf16 v[236:239], v[120:123], v[148:151], v[236:239]
    v_mfma_f32_16x16x32_bf16 v[216:219], v[24:27], v[152:155], v[216:219]
    s_add_u32 m0, s71, 22528
    s_add_u32 s68, s70, 344064
    v_mfma_f32_16x16x32_bf16 v[220:223], v[40:43], v[152:155], v[220:223]
    buffer_load_dwordx4 v245, s[28:31], s68 offen lds
    v_mfma_f32_16x16x32_bf16 v[224:227], v[56:59], v[152:155], v[224:227]
    v_mfma_f32_16x16x32_bf16 v[228:231], v[72:75], v[152:155], v[228:231]
    v_mfma_f32_16x16x32_bf16 v[232:235], v[88:91], v[152:155], v[232:235]
    s_add_u32 m0, s71, 23552
    s_add_u32 s68, s70, 344064
    v_mfma_f32_16x16x32_bf16 v[236:239], v[104:107], v[152:155], v[236:239]
    buffer_load_dwordx4 v246, s[28:31], s68 offen lds
    v_mfma_f32_16x16x32_bf16 v[220:223], v[24:27], v[156:159], v[220:223]
    v_mfma_f32_16x16x32_bf16 v[224:227], v[40:43], v[156:159], v[224:227]
    v_mfma_f32_16x16x32_bf16 v[228:231], v[56:59], v[156:159], v[228:231]
    s_add_u32 m0, s71, 24576
    s_add_u32 s68, s70, 344064
    v_mfma_f32_16x16x32_bf16 v[232:235], v[72:75], v[156:159], v[232:235]
    buffer_load_dwordx4 v247, s[28:31], s68 offen lds
    v_mfma_f32_16x16x32_bf16 v[236:239], v[88:91], v[156:159], v[236:239]
    v_mfma_f32_16x16x32_bf16 v[224:227], v[24:27], v[160:163], v[224:227]
    v_mfma_f32_16x16x32_bf16 v[228:231], v[40:43], v[160:163], v[228:231]
    s_add_u32 m0, s71, 25600
    s_add_u32 s68, s70, 344064
    v_mfma_f32_16x16x32_bf16 v[232:235], v[56:59], v[160:163], v[232:235]
    buffer_load_dwordx4 v248, s[28:31], s68 offen lds
    v_mfma_f32_16x16x32_bf16 v[236:239], v[72:75], v[160:163], v[236:239]
    v_mfma_f32_16x16x32_bf16 v[228:231], v[24:27], v[164:167], v[228:231]
    v_mfma_f32_16x16x32_bf16 v[232:235], v[40:43], v[164:167], v[232:235]
    s_add_u32 m0, s71, 26624
    s_add_u32 s68, s70, 344064
    v_mfma_f32_16x16x32_bf16 v[236:239], v[56:59], v[164:167], v[236:239]
    buffer_load_dwordx4 v249, s[28:31], s68 offen lds
    v_mfma_f32_16x16x32_bf16 v[232:235], v[24:27], v[168:171], v[232:235]
    v_mfma_f32_16x16x32_bf16 v[236:239], v[40:43], v[168:171], v[236:239]
    v_mfma_f32_16x16x32_bf16 v[236:239], v[24:27], v[172:175], v[236:239]
    s_waitcnt lgkmcnt(0)
    s_add_u32 m0, s71, 27648
    s_add_u32 s68, s70, 344064
    v_mfma_f32_16x16x32_bf16 v[208:211], v[28:31], v[176:179], v[208:211]
    buffer_load_dwordx4 v255, s[28:31], s68 offen lds
    v_mfma_f32_16x16x32_bf16 v[212:215], v[44:47], v[176:179], v[212:215]
    v_mfma_f32_16x16x32_bf16 v[216:219], v[60:63], v[176:179], v[216:219]
    v_mfma_f32_16x16x32_bf16 v[220:223], v[76:79], v[176:179], v[220:223]
    v_mfma_f32_16x16x32_bf16 v[224:227], v[92:95], v[176:179], v[224:227]
    s_mul_i32 s61, s3, 448
    s_lshr_b32 s62, s5, 3
    s_lshl_b32 s62, s62, 6
    s_add_u32 s61, s61, s62
    s_lshl_b32 s61, s61, 10
    s_lshl_b32 s62, s56, 7
    s_add_u32 s61, s61, s62
    v_lshlrev_b32 v6, 10, v0
    buffer_load_dword v250, v6, s[32:35], s61 offen
    v_mfma_f32_16x16x32_bf16 v[228:231], v[108:111], v[176:179], v[228:231]
    v_mfma_f32_16x16x32_bf16 v[232:235], v[124:127], v[176:179], v[232:235]
    v_mfma_f32_16x16x32_bf16 v[236:239], v[140:143], v[176:179], v[236:239]
    v_mfma_f32_16x16x32_bf16 v[212:215], v[28:31], v[180:183], v[212:215]
    v_mfma_f32_16x16x32_bf16 v[216:219], v[44:47], v[180:183], v[216:219]
    v_mfma_f32_16x16x32_bf16 v[220:223], v[60:63], v[180:183], v[220:223]
    v_mfma_f32_16x16x32_bf16 v[224:227], v[76:79], v[180:183], v[224:227]
    v_mfma_f32_16x16x32_bf16 v[228:231], v[92:95], v[180:183], v[228:231]
    v_mfma_f32_16x16x32_bf16 v[232:235], v[108:111], v[180:183], v[232:235]
    v_mfma_f32_16x16x32_bf16 v[236:239], v[124:127], v[180:183], v[236:239]
    v_mfma_f32_16x16x32_bf16 v[216:219], v[28:31], v[184:187], v[216:219]
    v_mfma_f32_16x16x32_bf16 v[220:223], v[44:47], v[184:187], v[220:223]
    v_mfma_f32_16x16x32_bf16 v[224:227], v[60:63], v[184:187], v[224:227]
    v_mfma_f32_16x16x32_bf16 v[228:231], v[76:79], v[184:187], v[228:231]
    v_mfma_f32_16x16x32_bf16 v[232:235], v[92:95], v[184:187], v[232:235]
    v_mfma_f32_16x16x32_bf16 v[236:239], v[108:111], v[184:187], v[236:239]
    v_mfma_f32_16x16x32_bf16 v[220:223], v[28:31], v[188:191], v[220:223]
    v_mfma_f32_16x16x32_bf16 v[224:227], v[44:47], v[188:191], v[224:227]
    v_mfma_f32_16x16x32_bf16 v[228:231], v[60:63], v[188:191], v[228:231]
    v_mfma_f32_16x16x32_bf16 v[232:235], v[76:79], v[188:191], v[232:235]
    v_mfma_f32_16x16x32_bf16 v[236:239], v[92:95], v[188:191], v[236:239]
    v_mfma_f32_16x16x32_bf16 v[224:227], v[28:31], v[192:195], v[224:227]
    v_mfma_f32_16x16x32_bf16 v[228:231], v[44:47], v[192:195], v[228:231]
    v_mfma_f32_16x16x32_bf16 v[232:235], v[60:63], v[192:195], v[232:235]
    v_mfma_f32_16x16x32_bf16 v[236:239], v[76:79], v[192:195], v[236:239]
    v_mfma_f32_16x16x32_bf16 v[228:231], v[28:31], v[196:199], v[228:231]
    v_mfma_f32_16x16x32_bf16 v[232:235], v[44:47], v[196:199], v[232:235]
    v_mfma_f32_16x16x32_bf16 v[236:239], v[60:63], v[196:199], v[236:239]
    v_mfma_f32_16x16x32_bf16 v[232:235], v[28:31], v[200:203], v[232:235]
    v_mfma_f32_16x16x32_bf16 v[236:239], v[44:47], v[200:203], v[236:239]
    v_mfma_f32_16x16x32_bf16 v[236:239], v[28:31], v[204:207], v[236:239]
    s_lshl_b32 s61, s3, 13
    s_add_u32 s61, s61, 123904
    v_add_u32 v5, s61, v1
    ds_write_b128 v5, v[208:211] offset:0
    ds_write_b128 v5, v[212:215] offset:1024
    ds_write_b128 v5, v[216:219] offset:2048
    ds_write_b128 v5, v[220:223] offset:3072
    ds_write_b128 v5, v[224:227] offset:4096
    ds_write_b128 v5, v[228:231] offset:5120
    ds_write_b128 v5, v[232:235] offset:6144
    ds_write_b128 v5, v[236:239] offset:7168
    s_waitcnt lgkmcnt(0)
    s_barrier
    s_lshl_b32 s61, s3, 11
    s_add_u32 s61, s61, 123904
    v_add_u32 v5, s61, v1
    ds_read_b128 v[16:19], v5 offset:0
    ds_read_b128 v[20:23], v5 offset:8192
    ds_read_b128 v[24:27], v5 offset:16384
    ds_read_b128 v[28:31], v5 offset:24576
    ds_read_b128 v[32:35], v5 offset:1024
    ds_read_b128 v[36:39], v5 offset:9216
    ds_read_b128 v[40:43], v5 offset:17408
    ds_read_b128 v[44:47], v5 offset:25600
    v_lshrrev_b32 v6, 1, v4
    v_lshl_add_u32 v6, v3, 1, v6
    v_lshlrev_b32 v6, 4, v6
    v_and_b32 v7, 1, v4
    v_xor_b32 v7, 1, v7
    v_lshl_add_u32 v6, v7, 3, v6
    s_lshl_b32 s61, s3, 10
    s_add_u32 s61, s61, 115200
    v_add_u32 v6, s61, v6
    ds_read_b64 v[48:49], v6 offset:0
    ds_read_b64 v[50:51], v6 offset:4608
    ds_read_b64 v[52:53], v6 offset:512
    ds_read_b64 v[54:55], v6 offset:5120
    v_accvgpr_read_b32 v8, a250
    v_lshlrev_b32 v9, 16, v8
    v_and_b32 v8, 0xffff0000, v8
    s_waitcnt lgkmcnt(0)
    v_pk_add_f32 v[16:17], v[16:17], v[20:21]
    v_pk_add_f32 v[18:19], v[18:19], v[22:23]
    v_and_b32 v10, 0xffff0000, v49
    v_fmac_f32 v16, v10, v9
    v_lshlrev_b32 v10, 16, v49
    v_fmac_f32 v17, v10, v9
    v_and_b32 v10, 0xffff0000, v48
    v_fmac_f32 v18, v10, v9
    v_lshlrev_b32 v10, 16, v48
    v_fmac_f32 v19, v10, v9
    v_pk_add_f32 v[24:25], v[24:25], v[28:29]
    v_pk_add_f32 v[26:27], v[26:27], v[30:31]
    v_and_b32 v10, 0xffff0000, v51
    v_fmac_f32 v24, v10, v8
    v_lshlrev_b32 v10, 16, v51
    v_fmac_f32 v25, v10, v8
    v_and_b32 v10, 0xffff0000, v50
    v_fmac_f32 v26, v10, v8
    v_lshlrev_b32 v10, 16, v50
    v_fmac_f32 v27, v10, v8
    v_cvt_pk_bf16_f32 v56, v16, v24
    v_cvt_pk_bf16_f32 v57, v17, v25
    v_cvt_pk_bf16_f32 v58, v18, v26
    v_cvt_pk_bf16_f32 v59, v19, v27
    v_pk_add_f32 v[32:33], v[32:33], v[36:37]
    v_pk_add_f32 v[34:35], v[34:35], v[38:39]
    v_and_b32 v10, 0xffff0000, v53
    v_fmac_f32 v32, v10, v9
    v_lshlrev_b32 v10, 16, v53
    v_fmac_f32 v33, v10, v9
    v_and_b32 v10, 0xffff0000, v52
    v_fmac_f32 v34, v10, v9
    v_lshlrev_b32 v10, 16, v52
    v_fmac_f32 v35, v10, v9
    v_pk_add_f32 v[40:41], v[40:41], v[44:45]
    v_pk_add_f32 v[42:43], v[42:43], v[46:47]
    v_and_b32 v10, 0xffff0000, v55
    v_fmac_f32 v40, v10, v8
    v_lshlrev_b32 v10, 16, v55
    v_fmac_f32 v41, v10, v8
    v_and_b32 v10, 0xffff0000, v54
    v_fmac_f32 v42, v10, v8
    v_lshlrev_b32 v10, 16, v54
    v_fmac_f32 v43, v10, v8
    v_cvt_pk_bf16_f32 v60, v32, v40
    v_cvt_pk_bf16_f32 v61, v33, v41
    v_cvt_pk_bf16_f32 v62, v34, v42
    v_cvt_pk_bf16_f32 v63, v35, v43
    v_lshlrev_b32 v5, 6, v3
    v_lshl_add_u32 v5, v4, 4, v5
    s_lshl_b32 s61, s64, 13
    s_lshl_b32 s62, s3, 11
    s_add_u32 s61, s61, s62
    s_add_u32 s61, s61, 2359296
    buffer_store_dwordx4 v[56:59], v5, s[8:11], s61 offen sc1
    buffer_store_dwordx4 v[60:63], v5, s[8:11], s61 offen offset:1024 sc1
    s_waitcnt vmcnt(0)
    s_barrier
    s_mov_b32 s65, 36864
    s_cmp_eq_u32 s3, 0
    s_cbranch_scc0 L_nf_8
    s_lshl_b32 s60, s2, 7
    s_add_u32 s60, s60, s65
    v_mov_b32 v5, s6
    s_mov_b64 exec, 1
    buffer_store_dword v5, off, s[8:11], s60 sc1
    s_mov_b64 exec, -1
L_nf_8:
    s_add_u32 s66, s3, 4
    s_min_u32 s66, s66, 6
    s_mul_i32 s61, s54, 224
    s_lshl_b32 s62, s3, 5
    s_add_u32 s62, s62, s61
    s_lshl_b32 s63, s66, 5
    s_add_u32 s63, s63, s61
    v_lshlrev_b32 v5, 3, v4
    buffer_load_dwordx2 v[16:17], v5, s[48:51], s62 offen
    buffer_load_dwordx2 v[18:19], v5, s[48:51], s63 offen
    s_lshl_b32 s61, s55, 12
    s_lshl_b32 s62, s3, 7
    s_add_u32 s61, s61, s62
    s_add_u32 s61, s61, 4456448
    v_lshlrev_b32 v11, 3, v3
    v_lshl_add_u32 v11, v4, 10, v11
    buffer_load_dwordx2 v[72:73], v11, s[8:11], s61 offen sc1
    buffer_load_dwordx2 v[74:75], v11, s[8:11], s61 offen offset:512 sc1
    s_mul_i32 s74, s3, 458752
    s_lshl_b32 s61, s56, 7
    s_add_u32 s74, s74, s61
    s_mul_i32 s72, s3, 12288
    s_add_u32 s72, s72, 114688
    v_lshlrev_b32 v244, 1, v4
    v_and_b32 v245, 7, v0
    v_xor_b32 v245, v245, v244
    v_lshrrev_b32 v244, 3, v0
    v_lshlrev_b32 v244, 10, v244
    v_lshl_add_u32 v244, v245, 4, v244
    v_lshrrev_b32 v245, 5, v0
    v_lshlrev_b32 v245, 12, v245
    v_add_u32 v245, v245, v244
    s_add_u32 m0, s72, 0
    s_add_u32 s75, s74, 0
    buffer_load_dwordx4 v244, s[32:35], s75 offen lds
    s_add_u32 m0, s72, 1024
    s_add_u32 s75, s74, 8192
    buffer_load_dwordx4 v244, s[32:35], s75 offen lds
    s_add_u32 m0, s72, 2048
    s_add_u32 s75, s74, 16384
    buffer_load_dwordx4 v244, s[32:35], s75 offen lds
    s_add_u32 m0, s72, 3072
    s_add_u32 s75, s74, 24576
    buffer_load_dwordx4 v244, s[32:35], s75 offen lds
    s_add_u32 m0, s72, 4096
    s_add_u32 s75, s74, 32768
    buffer_load_dwordx4 v244, s[32:35], s75 offen lds
    s_add_u32 m0, s72, 5120
    s_add_u32 s75, s74, 40960
    buffer_load_dwordx4 v244, s[32:35], s75 offen lds
    s_add_u32 m0, s72, 6144
    s_add_u32 s75, s74, 49152
    buffer_load_dwordx4 v244, s[32:35], s75 offen lds
    s_add_u32 m0, s72, 7168
    s_add_u32 s75, s74, 57344
    buffer_load_dwordx4 v244, s[32:35], s75 offen lds
    s_add_u32 m0, s72, 8192
    s_add_u32 s75, s74, 65536
    buffer_load_dwordx4 v244, s[32:35], s75 offen lds
    s_add_u32 m0, s72, 9216
    s_add_u32 s75, s74, 73728
    buffer_load_dwordx4 v244, s[32:35], s75 offen lds
    s_add_u32 m0, s72, 10240
    s_add_u32 s75, s74, 81920
    buffer_load_dwordx4 v244, s[32:35], s75 offen lds
    s_add_u32 m0, s72, 11264
    s_add_u32 s75, s74, 90112
    buffer_load_dwordx4 v244, s[32:35], s75 offen lds
    v_lshrrev_b32 v240, 2, v3
    v_lshl_add_u32 v241, v4, 2, v240
    v_lshlrev_b32 v241, 7, v241
    v_lshrrev_b32 v240, 1, v240
    v_lshl_add_u32 v240, v4, 1, v240
    v_and_b32 v240, 3, v240
    v_and_b32 v242, 3, v3
    v_lshrrev_b32 v243, 1, v242
    v_lshl_add_u32 v241, v243, 4, v241
    v_and_b32 v242, 1, v242
    v_lshl_add_u32 v241, v242, 3, v241
    v_add_u32 v241, s72, v241
    v_xor_b32 v242, 0, v240
    v_lshl_add_u32 v236, v242, 5, v241
    v_xor_b32 v242, 1, v240
    v_lshl_add_u32 v237, v242, 5, v241
    v_xor_b32 v242, 2, v240
    v_lshl_add_u32 v238, v242, 5, v241
    v_xor_b32 v242, 3, v240
    v_lshl_add_u32 v239, v242, 5, v241
    v_lshrrev_b32 v7, 2, v3
    v_lshl_add_u32 v7, v4, 2, v7
    v_mul_u32_u24 v7, 224, v7
    v_and_b32 v8, 3, v3
    v_lshl_add_u32 v7, v8, 3, v7
    s_lshl_b32 s61, s3, 5
    s_lshl_b32 s62, s66, 5
    v_add_u32 v8, s62, v7
    v_add_u32 v7, s61, v7
    v_add_u32 v9, 57344, v7
    v_add_u32 v10, 57344, v8
    v_mov_b32 v20, 0x3f803f80
    v_mov_b32 v21, 0x3f803f80
    v_mov_b32 v22, 0x3f803f80
    v_mov_b32 v23, 0x3f803f80
    ds_read_b64_tr_b16 v[32:33], v7 offset:0
    ds_read_b64_tr_b16 v[34:35], v7 offset:3584
    ds_read_b64_tr_b16 v[36:37], v8 offset:0
    ds_read_b64_tr_b16 v[38:39], v8 offset:3584
    ds_read_b64_tr_b16 v[40:41], v7 offset:7168
    ds_read_b64_tr_b16 v[42:43], v7 offset:10752
    ds_read_b64_tr_b16 v[44:45], v8 offset:7168
    ds_read_b64_tr_b16 v[46:47], v8 offset:10752
    ds_read_b64_tr_b16 v[48:49], v7 offset:14336
    ds_read_b64_tr_b16 v[50:51], v7 offset:17920
    ds_read_b64_tr_b16 v[52:53], v8 offset:14336
    ds_read_b64_tr_b16 v[54:55], v8 offset:17920
    s_waitcnt lgkmcnt(8)
    v_mfma_f32_16x16x32_bf16 v[24:27], v[32:35], v[20:23], 0
    v_mfma_f32_16x16x32_bf16 v[28:31], v[36:39], v[20:23], 0
    ds_read_b64_tr_b16 v[56:57], v7 offset:21504
    ds_read_b64_tr_b16 v[58:59], v7 offset:25088
    ds_read_b64_tr_b16 v[60:61], v8 offset:21504
    ds_read_b64_tr_b16 v[62:63], v8 offset:25088
    s_waitcnt lgkmcnt(8)
    v_mfma_f32_16x16x32_bf16 v[24:27], v[40:43], v[20:23], v[24:27]
    v_mfma_f32_16x16x32_bf16 v[28:31], v[44:47], v[20:23], v[28:31]
    ds_read_b64_tr_b16 v[32:33], v7 offset:28672
    ds_read_b64_tr_b16 v[34:35], v7 offset:32256
    ds_read_b64_tr_b16 v[36:37], v8 offset:28672
    ds_read_b64_tr_b16 v[38:39], v8 offset:32256
    s_waitcnt lgkmcnt(8)
    v_mfma_f32_16x16x32_bf16 v[24:27], v[48:51], v[20:23], v[24:27]
    v_mfma_f32_16x16x32_bf16 v[28:31], v[52:55], v[20:23], v[28:31]
    ds_read_b64_tr_b16 v[40:41], v7 offset:35840
    ds_read_b64_tr_b16 v[42:43], v7 offset:39424
    ds_read_b64_tr_b16 v[44:45], v8 offset:35840
    ds_read_b64_tr_b16 v[46:47], v8 offset:39424
    s_waitcnt lgkmcnt(8)
    v_mfma_f32_16x16x32_bf16 v[24:27], v[56:59], v[20:23], v[24:27]
    v_mfma_f32_16x16x32_bf16 v[28:31], v[60:63], v[20:23], v[28:31]
    ds_read_b64_tr_b16 v[48:49], v7 offset:43008
    ds_read_b64_tr_b16 v[50:51], v7 offset:46592
    ds_read_b64_tr_b16 v[52:53], v8 offset:43008
    ds_read_b64_tr_b16 v[54:55], v8 offset:46592
    s_waitcnt lgkmcnt(8)
    v_mfma_f32_16x16x32_bf16 v[24:27], v[32:35], v[20:23], v[24:27]
    v_mfma_f32_16x16x32_bf16 v[28:31], v[36:39], v[20:23], v[28:31]
    ds_read_b64_tr_b16 v[56:57], v7 offset:50176
    ds_read_b64_tr_b16 v[58:59], v7 offset:53760
    ds_read_b64_tr_b16 v[60:61], v8 offset:50176
    ds_read_b64_tr_b16 v[62:63], v8 offset:53760
    s_waitcnt lgkmcnt(8)
    v_mfma_f32_16x16x32_bf16 v[24:27], v[40:43], v[20:23], v[24:27]
    v_mfma_f32_16x16x32_bf16 v[28:31], v[44:47], v[20:23], v[28:31]
    ds_read_b64_tr_b16 v[32:33], v9 offset:0
    ds_read_b64_tr_b16 v[34:35], v9 offset:3584
    ds_read_b64_tr_b16 v[36:37], v10 offset:0
    ds_read_b64_tr_b16 v[38:39], v10 offset:3584
    s_waitcnt lgkmcnt(8)
    v_mfma_f32_16x16x32_bf16 v[24:27], v[48:51], v[20:23], v[24:27]
    v_mfma_f32_16x16x32_bf16 v[28:31], v[52:55], v[20:23], v[28:31]
    ds_read_b64_tr_b16 v[40:41], v9 offset:7168
    ds_read_b64_tr_b16 v[42:43], v9 offset:10752
    ds_read_b64_tr_b16 v[44:45], v10 offset:7168
    ds_read_b64_tr_b16 v[46:47], v10 offset:10752
    s_waitcnt lgkmcnt(8)
    v_mfma_f32_16x16x32_bf16 v[24:27], v[56:59], v[20:23], v[24:27]
    v_mfma_f32_16x16x32_bf16 v[28:31], v[60:63], v[20:23], v[28:31]
    ds_read_b64_tr_b16 v[48:49], v9 offset:14336
    ds_read_b64_tr_b16 v[50:51], v9 offset:17920
    ds_read_b64_tr_b16 v[52:53], v10 offset:14336
    ds_read_b64_tr_b16 v[54:55], v10 offset:17920
    s_waitcnt lgkmcnt(8)
    v_mfma_f32_16x16x32_bf16 v[24:27], v[32:35], v[20:23], v[24:27]
    v_mfma_f32_16x16x32_bf16 v[28:31], v[36:39], v[20:23], v[28:31]
    ds_read_b64_tr_b16 v[56:57], v9 offset:21504
    ds_read_b64_tr_b16 v[58:59], v9 offset:25088
    ds_read_b64_tr_b16 v[60:61], v10 offset:21504
    ds_read_b64_tr_b16 v[62:63], v10 offset:25088
    s_waitcnt lgkmcnt(8)
    v_mfma_f32_16x16x32_bf16 v[24:27], v[40:43], v[20:23], v[24:27]
    v_mfma_f32_16x16x32_bf16 v[28:31], v[44:47], v[20:23], v[28:31]
    ds_read_b64_tr_b16 v[32:33], v9 offset:28672
    ds_read_b64_tr_b16 v[34:35], v9 offset:32256
    ds_read_b64_tr_b16 v[36:37], v10 offset:28672
    ds_read_b64_tr_b16 v[38:39], v10 offset:32256
    s_waitcnt lgkmcnt(8)
    v_mfma_f32_16x16x32_bf16 v[24:27], v[48:51], v[20:23], v[24:27]
    v_mfma_f32_16x16x32_bf16 v[28:31], v[52:55], v[20:23], v[28:31]
    ds_read_b64_tr_b16 v[40:41], v9 offset:35840
    ds_read_b64_tr_b16 v[42:43], v9 offset:39424
    ds_read_b64_tr_b16 v[44:45], v10 offset:35840
    ds_read_b64_tr_b16 v[46:47], v10 offset:39424
    s_waitcnt lgkmcnt(8)
    v_mfma_f32_16x16x32_bf16 v[24:27], v[56:59], v[20:23], v[24:27]
    v_mfma_f32_16x16x32_bf16 v[28:31], v[60:63], v[20:23], v[28:31]
    ds_read_b64_tr_b16 v[48:49], v9 offset:43008
    ds_read_b64_tr_b16 v[50:51], v9 offset:46592
    ds_read_b64_tr_b16 v[52:53], v10 offset:43008
    ds_read_b64_tr_b16 v[54:55], v10 offset:46592
    s_waitcnt lgkmcnt(8)
    v_mfma_f32_16x16x32_bf16 v[24:27], v[32:35], v[20:23], v[24:27]
    v_mfma_f32_16x16x32_bf16 v[28:31], v[36:39], v[20:23], v[28:31]
    ds_read_b64_tr_b16 v[56:57], v9 offset:50176
    ds_read_b64_tr_b16 v[58:59], v9 offset:53760
    ds_read_b64_tr_b16 v[60:61], v10 offset:50176
    ds_read_b64_tr_b16 v[62:63], v10 offset:53760
    s_waitcnt lgkmcnt(8)
    v_mfma_f32_16x16x32_bf16 v[24:27], v[40:43], v[20:23], v[24:27]
    v_mfma_f32_16x16x32_bf16 v[28:31], v[44:47], v[20:23], v[28:31]
    s_waitcnt lgkmcnt(4)
    v_mfma_f32_16x16x32_bf16 v[24:27], v[48:51], v[20:23], v[24:27]
    v_mfma_f32_16x16x32_bf16 v[28:31], v[52:55], v[20:23], v[28:31]
    s_waitcnt lgkmcnt(0)
    v_mfma_f32_16x16x32_bf16 v[24:27], v[56:59], v[20:23], v[24:27]
    v_mfma_f32_16x16x32_bf16 v[28:31], v[60:63], v[20:23], v[28:31]
    s_waitcnt vmcnt(12)
    v_lshlrev_b32 v64, 16, v16
    v_and_b32 v65, 0xffff0000, v16
    v_lshlrev_b32 v66, 16, v17
    v_and_b32 v67, 0xffff0000, v17
    v_mul_f32 v64, 0x3fb8aa3b, v64
    v_mul_f32 v65, 0x3fb8aa3b, v65
    v_mul_f32 v66, 0x3fb8aa3b, v66
    v_mul_f32 v67, 0x3fb8aa3b, v67
    v_lshlrev_b32 v68, 16, v18
    v_and_b32 v69, 0xffff0000, v18
    v_lshlrev_b32 v70, 16, v19
    v_and_b32 v71, 0xffff0000, v19
    v_mul_f32 v68, 0x3fb8aa3b, v68
    v_mul_f32 v69, 0x3fb8aa3b, v69
    v_mul_f32 v70, 0x3fb8aa3b, v70
    v_mul_f32 v71, 0x3fb8aa3b, v71
    v_lshlrev_b32 v5, 4, v4
    s_lshl_b32 s61, s2, 10
    s_add_u32 s61, s61, 4980736
    s_lshl_b32 s62, s3, 6
    s_add_u32 s62, s62, s61
    s_lshl_b32 s63, s66, 6
    s_add_u32 s63, s63, s61
    buffer_store_dwordx4 v[24:27], v5, s[8:11], s62 offen
    buffer_store_dwordx4 v[28:31], v5, s[8:11], s63 offen
    buffer_store_dwordx4 v[64:67], v5, s[8:11], s62 offen offset:512
    buffer_store_dwordx4 v[68:71], v5, s[8:11], s63 offen offset:512
    s_waitcnt vmcnt(0)
    s_barrier
    v_pk_add_f32 v[72:73], v[72:73], v[74:75]
    v_mov_b32 v74, v72
    v_mov_b32 v75, v73
    s_nop 0
    v_permlane16_swap_b32 v72, v74
    v_permlane16_swap_b32 v73, v75
    v_pk_add_f32 v[72:73], v[72:73], v[74:75]
    v_mov_b32 v74, v72
    v_mov_b32 v75, v73
    s_nop 0
    v_permlane32_swap_b32 v72, v74
    v_permlane32_swap_b32 v73, v75
    v_pk_add_f32 v[72:73], v[72:73], v[74:75]
    v_mul_f32 v72, 0x3b000000, v72
    v_mul_f32 v73, 0x3b000000, v73
    v_fma_f32 v73, -v72, v72, v73
    v_max_f32 v73, 0, v73
    v_add_f32 v73, 0x3727c5ac, v73
    v_rsq_f32 v14, v73
    s_nop 0
    v_mul_f32 v15, -v72, v14
    v_accvgpr_write_b32 a248, v14
    v_accvgpr_write_b32 a249, v15
    ds_read_b64_tr_b16 a[0:1], v236 offset:0
    ds_read_b64_tr_b16 a[2:3], v236 offset:2048
    ds_read_b64_tr_b16 a[4:5], v237 offset:0
    ds_read_b64_tr_b16 a[6:7], v237 offset:2048
    ds_read_b64_tr_b16 a[8:9], v238 offset:0
    ds_read_b64_tr_b16 a[10:11], v238 offset:2048
    ds_read_b64_tr_b16 a[12:13], v239 offset:0
    ds_read_b64_tr_b16 a[14:15], v239 offset:2048
    s_waitcnt lgkmcnt(6)
    ds_read_b64_tr_b16 a[16:17], v236 offset:4096
    ds_read_b64_tr_b16 a[18:19], v236 offset:6144
    ds_read_b64_tr_b16 a[20:21], v237 offset:4096
    ds_read_b64_tr_b16 a[22:23], v237 offset:6144
    ds_read_b64_tr_b16 a[24:25], v238 offset:4096
    ds_read_b64_tr_b16 a[26:27], v238 offset:6144
    ds_read_b64_tr_b16 a[28:29], v239 offset:4096
    ds_read_b64_tr_b16 a[30:31], v239 offset:6144
    s_waitcnt lgkmcnt(6)
    ds_read_b64_tr_b16 a[32:33], v236 offset:8192
    ds_read_b64_tr_b16 a[34:35], v236 offset:10240
    ds_read_b64_tr_b16 a[36:37], v237 offset:8192
    ds_read_b64_tr_b16 a[38:39], v237 offset:10240
    ds_read_b64_tr_b16 a[40:41], v238 offset:8192
    ds_read_b64_tr_b16 a[42:43], v238 offset:10240
    ds_read_b64_tr_b16 a[44:45], v239 offset:8192
    ds_read_b64_tr_b16 a[46:47], v239 offset:10240
    s_waitcnt lgkmcnt(6)
    s_waitcnt lgkmcnt(0)
    s_lshl_b32 s61, s56, 7
    s_add_u32 s61, s61, 36864
    s_cmp_eq_u32 s3, 0
    s_cbranch_scc0 L_skip_9
    v_lshlrev_b32 v5, 10, v0
    s_mov_b32 exec_lo, 0xffffffff
    s_mov_b32 exec_hi, 0
    s_mov_b32 s62, 0
L_poll_10:
    buffer_load_dword v6, v5, s[8:11], s61 offen sc1
    s_add_u32 s62, s62, 1
    s_cmp_gt_u32 s62, s58
    s_cbranch_scc1 L_to_12
    s_waitcnt vmcnt(0)
    v_cmp_ne_u32 vcc, s6, v6
    s_cmp_eq_u64 vcc, 0
    s_cbranch_scc0 L_poll_10
    s_branch L_ok_11
L_to_12:
    s_mov_b32 s58, 0
    s_waitcnt vmcnt(0)
L_ok_11:
    s_mov_b64 exec, -1
L_skip_9:
    s_barrier
    v_lshlrev_b32 v5, 14, v4
    v_lshl_add_u32 v5, v3, 2, v5
    s_lshl_b32 s61, s56, 18
    s_lshl_b32 s62, s55, 8
    s_add_u32 s61, s61, s62
    s_lshl_b32 s62, s3, 6
    s_add_u32 s61, s61, s62
    s_add_u32 s61, s61, 2359296
    s_add_u32 s62, s61, 0
    buffer_load_dword a240, v5, s[8:11], s62 offen sc1
    s_add_u32 s62, s61, 8192
    buffer_load_dword a241, v5, s[8:11], s62 offen sc1
    s_add_u32 s62, s61, 65536
    buffer_load_dword a242, v5, s[8:11], s62 offen sc1
    s_add_u32 s62, s61, 73728
    buffer_load_dword a243, v5, s[8:11], s62 offen sc1
    s_add_u32 s62, s61, 131072
    buffer_load_dword a244, v5, s[8:11], s62 offen sc1
    s_add_u32 s62, s61, 139264
    buffer_load_dword a245, v5, s[8:11], s62 offen sc1
    s_add_u32 s62, s61, 196608
    buffer_load_dword a246, v5, s[8:11], s62 offen sc1
    s_add_u32 s62, s61, 204800
    buffer_load_dword a247, v5, s[8:11], s62 offen sc1
    s_add_u32 m0, s72, 0
    s_add_u32 s75, s74, 98304
    buffer_load_dwordx4 v245, s[32:35], s75 offen lds
    s_add_u32 m0, s72, 1024
    s_add_u32 s75, s74, 212992
    buffer_load_dwordx4 v245, s[32:35], s75 offen lds
    s_add_u32 m0, s72, 2048
    s_add_u32 s75, s74, 102400
    buffer_load_dwordx4 v245, s[32:35], s75 offen lds
    s_add_u32 m0, s72, 3072
    s_add_u32 s75, s74, 217088
    buffer_load_dwordx4 v245, s[32:35], s75 offen lds
    s_add_u32 m0, s72, 4096
    s_add_u32 s75, s74, 114688
    buffer_load_dwordx4 v244, s[32:35], s75 offen lds
    s_add_u32 m0, s72, 5120
    s_add_u32 s75, s74, 122880
    buffer_load_dwordx4 v244, s[32:35], s75 offen lds
    s_add_u32 m0, s72, 6144
    s_add_u32 s75, s74, 131072
    buffer_load_dwordx4 v244, s[32:35], s75 offen lds
    s_add_u32 m0, s72, 7168
    s_add_u32 s75, s74, 139264
    buffer_load_dwordx4 v244, s[32:35], s75 offen lds
    s_add_u32 m0, s72, 8192
    s_add_u32 s75, s74, 147456
    buffer_load_dwordx4 v244, s[32:35], s75 offen lds
    s_add_u32 m0, s72, 9216
    s_add_u32 s75, s74, 155648
    buffer_load_dwordx4 v244, s[32:35], s75 offen lds
    s_add_u32 m0, s72, 10240
    s_add_u32 s75, s74, 163840
    buffer_load_dwordx4 v244, s[32:35], s75 offen lds
    s_add_u32 m0, s72, 11264
    s_add_u32 s75, s74, 172032
    buffer_load_dwordx4 v244, s[32:35], s75 offen lds
    s_waitcnt vmcnt(12)
L_round:
    v_accvgpr_read_b32 v16, a224
    v_accvgpr_read_b32 v17, a225
    v_accvgpr_read_b32 v18, a226
    v_accvgpr_read_b32 v19, a227
    v_accvgpr_read_b32 v20, a228
    v_accvgpr_read_b32 v21, a229
    v_accvgpr_read_b32 v22, a230
    v_accvgpr_read_b32 v23, a231
    v_accvgpr_read_b32 v24, a232
    v_accvgpr_read_b32 v25, a233
    v_accvgpr_read_b32 v26, a234
    v_accvgpr_read_b32 v27, a235
    v_accvgpr_read_b32 v28, a236
    v_accvgpr_read_b32 v29, a237
    v_accvgpr_read_b32 v30, a238
    v_accvgpr_read_b32 v31, a239
    v_accvgpr_read_b32 v48, a240
    v_accvgpr_read_b32 v49, a241
    v_accvgpr_read_b32 v50, a242
    v_accvgpr_read_b32 v51, a243
    v_accvgpr_read_b32 v52, a244
    v_accvgpr_read_b32 v53, a245
    v_accvgpr_read_b32 v54, a246
    v_accvgpr_read_b32 v55, a247
    v_accvgpr_read_b32 v8, a248
    v_accvgpr_read_b32 v9, a249
    v_lshlrev_b32 v56, 16, v48
    v_and_b32 v57, 0xffff0000, v48
    v_pk_fma_f32 v[58:59], v[16:17], v[8:9], v[8:9] op_sel:[0,0,1] op_sel_hi:[1,0,1]
    v_pk_fma_f32 v[16:17], v[58:59], v[56:57], v[16:17]
    v_lshlrev_b32 v56, 16, v49
    v_and_b32 v57, 0xffff0000, v49
    v_pk_fma_f32 v[58:59], v[18:19], v[8:9], v[8:9] op_sel:[0,0,1] op_sel_hi:[1,0,1]
    v_pk_fma_f32 v[18:19], v[58:59], v[56:57], v[18:19]
    v_lshlrev_b32 v56, 16, v50
    v_and_b32 v57, 0xffff0000, v50
    v_pk_fma_f32 v[58:59], v[20:21], v[8:9], v[8:9] op_sel:[0,0,1] op_sel_hi:[1,0,1]
    v_pk_fma_f32 v[20:21], v[58:59], v[56:57], v[20:21]
    v_lshlrev_b32 v56, 16, v51
    v_and_b32 v57, 0xffff0000, v51
    v_pk_fma_f32 v[58:59], v[22:23], v[8:9], v[8:9] op_sel:[0,0,1] op_sel_hi:[1,0,1]
    v_pk_fma_f32 v[22:23], v[58:59], v[56:57], v[22:23]
    v_lshlrev_b32 v56, 16, v52
    v_and_b32 v57, 0xffff0000, v52
    v_pk_fma_f32 v[58:59], v[24:25], v[8:9], v[8:9] op_sel:[0,0,1] op_sel_hi:[1,0,1]
    v_pk_fma_f32 v[24:25], v[58:59], v[56:57], v[24:25]
    v_lshlrev_b32 v56, 16, v53
    v_and_b32 v57, 0xffff0000, v53
    v_pk_fma_f32 v[58:59], v[26:27], v[8:9], v[8:9] op_sel:[0,0,1] op_sel_hi:[1,0,1]
    v_pk_fma_f32 v[26:27], v[58:59], v[56:57], v[26:27]
    v_lshlrev_b32 v56, 16, v54
    v_and_b32 v57, 0xffff0000, v54
    v_pk_fma_f32 v[58:59], v[28:29], v[8:9], v[8:9] op_sel:[0,0,1] op_sel_hi:[1,0,1]
    v_pk_fma_f32 v[28:29], v[58:59], v[56:57], v[28:29]
    v_lshlrev_b32 v56, 16, v55
    v_and_b32 v57, 0xffff0000, v55
    v_pk_fma_f32 v[58:59], v[30:31], v[8:9], v[8:9] op_sel:[0,0,1] op_sel_hi:[1,0,1]
    v_pk_fma_f32 v[30:31], v[58:59], v[56:57], v[30:31]
    v_accvgpr_write_b32 a224, v16
    v_accvgpr_write_b32 a225, v17
    v_accvgpr_write_b32 a226, v18
    v_accvgpr_write_b32 a227, v19
    v_accvgpr_write_b32 a228, v20
    v_accvgpr_write_b32 a229, v21
    v_accvgpr_write_b32 a230, v22
    v_accvgpr_write_b32 a231, v23
    v_accvgpr_write_b32 a232, v24
    v_accvgpr_write_b32 a233, v25
    v_accvgpr_write_b32 a234, v26
    v_accvgpr_write_b32 a235, v27
    v_accvgpr_write_b32 a236, v28
    v_accvgpr_write_b32 a237, v29
    v_accvgpr_write_b32 a238, v30
    v_accvgpr_write_b32 a239, v31
    v_cvt_pk_bf16_f32 v40, v16, v17
    v_cvt_pk_bf16_f32 v41, v18, v19
    v_cvt_pk_bf16_f32 v42, v20, v21
    v_cvt_pk_bf16_f32 v43, v22, v23
    v_cvt_pk_bf16_f32 v44, v24, v25
    v_cvt_pk_bf16_f32 v45, v26, v27
    v_cvt_pk_bf16_f32 v46, v28, v29
    v_cvt_pk_bf16_f32 v47, v30, v31
    v_pk_add_f32 v[62:63], v[16:17], v[18:19]
    v_pk_mul_f32 v[64:65], v[16:17], v[16:17]
    v_pk_fma_f32 v[64:65], v[18:19], v[18:19], v[64:65]
    v_pk_add_f32 v[62:63], v[62:63], v[20:21]
    v_pk_fma_f32 v[64:65], v[20:21], v[20:21], v[64:65]
    v_pk_add_f32 v[62:63], v[62:63], v[22:23]
    v_pk_fma_f32 v[64:65], v[22:23], v[22:23], v[64:65]
    v_pk_add_f32 v[62:63], v[62:63], v[24:25]
    v_pk_fma_f32 v[64:65], v[24:25], v[24:25], v[64:65]
    v_pk_add_f32 v[62:63], v[62:63], v[26:27]
    v_pk_fma_f32 v[64:65], v[26:27], v[26:27], v[64:65]
    v_pk_add_f32 v[62:63], v[62:63], v[28:29]
    v_pk_fma_f32 v[64:65], v[28:29], v[28:29], v[64:65]
    v_pk_add_f32 v[62:63], v[62:63], v[30:31]
    v_pk_fma_f32 v[64:65], v[30:31], v[30:31], v[64:65]
    v_add_f32 v60, v62, v63
    v_add_f32 v61, v64, v65
    v_mov_b32 v62, v60
    v_mov_b32 v63, v61
    s_nop 0
    v_permlane16_swap_b32 v60, v62
    v_permlane16_swap_b32 v61, v63
    v_pk_add_f32 v[60:61], v[60:61], v[62:63]
    v_mov_b32 v62, v60
    v_mov_b32 v63, v61
    s_nop 0
    v_permlane32_swap_b32 v60, v62
    v_permlane32_swap_b32 v61, v63
    v_pk_add_f32 v[60:61], v[60:61], v[62:63]
    s_lshl_b32 s61, s53, 3
    s_lshl_b32 s62, s59, 2
    s_add_u32 s61, s61, s62
    s_add_u32 s61, s61, s3
    s_lshl_b32 s61, s61, 14
    s_lshl_b32 s62, s56, 11
    s_add_u32 s61, s61, s62
    s_lshl_b32 s62, s57, 31
    s_and_b32 s62, s62, 0x7fffffff
    s_add_u32 s61, s61, s62
    s_add_u32 s61, s61, 5242880
    v_lshlrev_b32 v9, 3, v3
    s_lshl_b32 s62, s55, 12
    s_lshl_b32 s63, s56, 9
    s_add_u32 s62, s62, s63
    s_lshl_b32 s63, s3, 7
    s_add_u32 s62, s62, s63
    s_lshl_b32 s63, s57, 18
    s_add_u32 s62, s62, s63
    s_add_u32 s62, s62, 4587520
    s_cmp_eq_u32 s7, 1
    s_cbranch_scc1 L_fast_13
    buffer_store_dwordx4 v[40:43], v1, s[8:11], s61 offen sc1
    buffer_store_dwordx4 v[44:47], v1, s[8:11], s61 offen offset:1024 sc1
    buffer_store_dwordx2 v[60:61], v9, s[8:11], s62 offen sc1
    s_branch L_done_14
L_fast_13:
    buffer_store_dwordx4 v[40:43], v1, s[8:11], s61 offen
    buffer_store_dwordx4 v[44:47], v1, s[8:11], s61 offen offset:1024
    buffer_store_dwordx2 v[60:61], v9, s[8:11], s62 offen
L_done_14:
    s_waitcnt vmcnt(0)
    s_mul_i32 s65, s57, 98304
    s_add_u32 s65, s65, 69632
    s_lshl_b32 s60, s2, 7
    s_add_u32 s60, s60, s65
    s_lshl_b32 s62, s3, 5
    s_add_u32 s60, s60, s62
    v_mov_b32 v5, s6
    s_mov_b64 exec, 1
    s_cmp_eq_u32 s7, 1
    s_cbranch_scc1 L_fast_15
    buffer_store_dword v5, off, s[8:11], s60 sc1
    s_branch L_done_16
L_fast_15:
    buffer_store_dword v5, off, s[8:11], s60
L_done_16:
    s_mov_b64 exec, -1
    s_cmp_eq_u32 s57, 0
    s_cbranch_scc0 L_r0_17
    ds_read_b64_tr_b16 a[48:49], v236 offset:0
    ds_read_b64_tr_b16 a[50:51], v236 offset:2048
    ds_read_b64_tr_b16 a[52:53], v237 offset:0
    ds_read_b64_tr_b16 a[54:55], v237 offset:2048
    ds_read_b64_tr_b16 a[56:57], v238 offset:0
    ds_read_b64_tr_b16 a[58:59], v238 offset:2048
    ds_read_b64_tr_b16 a[60:61], v239 offset:0
    ds_read_b64_tr_b16 a[62:63], v239 offset:2048
    s_waitcnt lgkmcnt(6)
    ds_read_b64_tr_b16 a[64:65], v236 offset:4096
    ds_read_b64_tr_b16 a[66:67], v236 offset:6144
    ds_read_b64_tr_b16 a[68:69], v237 offset:4096
    ds_read_b64_tr_b16 a[70:71], v237 offset:6144
    ds_read_b64_tr_b16 a[72:73], v238 offset:4096
    ds_read_b64_tr_b16 a[74:75], v238 offset:6144
    ds_read_b64_tr_b16 a[76:77], v239 offset:4096
    ds_read_b64_tr_b16 a[78:79], v239 offset:6144
    s_waitcnt lgkmcnt(6)
    ds_read_b64_tr_b16 a[80:81], v236 offset:8192
    ds_read_b64_tr_b16 a[82:83], v236 offset:10240
    ds_read_b64_tr_b16 a[84:85], v237 offset:8192
    ds_read_b64_tr_b16 a[86:87], v237 offset:10240
    ds_read_b64_tr_b16 a[88:89], v238 offset:8192
    ds_read_b64_tr_b16 a[90:91], v238 offset:10240
    ds_read_b64_tr_b16 a[92:93], v239 offset:8192
    ds_read_b64_tr_b16 a[94:95], v239 offset:10240
    s_waitcnt lgkmcnt(6)
    s_waitcnt lgkmcnt(0)
L_r0_17:
    v_and_b32 v5, 7, v3
    v_min_u32 v5, 6, v5
    v_lshlrev_b32 v5, 6, v5
    v_lshl_add_u32 v5, v4, 4, v5
    v_lshrrev_b32 v6, 3, v3
    v_lshl_add_u32 v5, v6, 9, v5
    s_lshl_b32 s61, s2, 10
    s_add_u32 s61, s61, 4980736
    buffer_load_dwordx4 v[136:139], v5, s[8:11], s61 offen sc1
    s_cmp_eq_u32 s57, 0
    s_cbranch_scc0 L_tb_18
    s_add_u32 m0, s72, 0
    s_add_u32 s75, s74, 180224
    buffer_load_dwordx4 v244, s[32:35], s75 offen lds
    s_add_u32 m0, s72, 1024
    s_add_u32 s75, s74, 188416
    buffer_load_dwordx4 v244, s[32:35], s75 offen lds
    s_add_u32 m0, s72, 2048
    s_add_u32 s75, s74, 196608
    buffer_load_dwordx4 v244, s[32:35], s75 offen lds
    s_add_u32 m0, s72, 3072
    s_add_u32 s75, s74, 204800
    buffer_load_dwordx4 v244, s[32:35], s75 offen lds
    s_add_u32 m0, s72, 4096
    s_add_u32 s75, s74, 229376
    buffer_load_dwordx4 v244, s[32:35], s75 offen lds
    s_add_u32 m0, s72, 5120
    s_add_u32 s75, s74, 237568
    buffer_load_dwordx4 v244, s[32:35], s75 offen lds
    s_add_u32 m0, s72, 6144
    s_add_u32 s75, s74, 245760
    buffer_load_dwordx4 v244, s[32:35], s75 offen lds
    s_add_u32 m0, s72, 7168
    s_add_u32 s75, s74, 253952
    buffer_load_dwordx4 v244, s[32:35], s75 offen lds
    s_add_u32 m0, s72, 8192
    s_add_u32 s75, s74, 262144
    buffer_load_dwordx4 v244, s[32:35], s75 offen lds
    s_add_u32 m0, s72, 9216
    s_add_u32 s75, s74, 270336
    buffer_load_dwordx4 v244, s[32:35], s75 offen lds
    s_add_u32 m0, s72, 10240
    s_add_u32 s75, s74, 278528
    buffer_load_dwordx4 v244, s[32:35], s75 offen lds
    s_add_u32 m0, s72, 11264
    s_add_u32 s75, s74, 286720
    buffer_load_dwordx4 v244, s[32:35], s75 offen lds
    s_lshr_b32 s62, s5, 3
    s_mul_i32 s62, s62, 48
    s_mul_i32 s63, s3, 448
    s_add_u32 s62, s62, s63
    s_add_u32 s62, s62, 256
    s_lshl_b32 s62, s62, 10
    s_lshl_b32 s63, s56, 7
    s_add_u32 s62, s62, s63
    v_lshlrev_b32 v6, 10, v0
    buffer_load_dword v15, v6, s[32:35], s62 offen
    s_waitcnt vmcnt(13)
    s_branch L_tb_19
L_tb_18:
    s_waitcnt vmcnt(0)
L_tb_19:
    v_mov_b32_dpp v80, v136 row_newbcast:0 row_mask:0xf bank_mask:0xf
    v_mov_b32_dpp v108, v136 row_newbcast:8 row_mask:0xf bank_mask:0xf
    v_mov_b32_dpp v81, v137 row_newbcast:0 row_mask:0xf bank_mask:0xf
    v_mov_b32_dpp v109, v137 row_newbcast:8 row_mask:0xf bank_mask:0xf
    v_mov_b32_dpp v82, v138 row_newbcast:0 row_mask:0xf bank_mask:0xf
    v_mov_b32_dpp v110, v138 row_newbcast:8 row_mask:0xf bank_mask:0xf
    v_mov_b32_dpp v83, v139 row_newbcast:0 row_mask:0xf bank_mask:0xf
    v_mov_b32_dpp v111, v139 row_newbcast:8 row_mask:0xf bank_mask:0xf
    v_mov_b32_dpp v84, v136 row_newbcast:1 row_mask:0xf bank_mask:0xf
    v_mov_b32_dpp v112, v136 row_newbcast:9 row_mask:0xf bank_mask:0xf
    v_mov_b32_dpp v85, v137 row_newbcast:1 row_mask:0xf bank_mask:0xf
    v_mov_b32_dpp v113, v137 row_newbcast:9 row_mask:0xf bank_mask:0xf
    v_mov_b32_dpp v86, v138 row_newbcast:1 row_mask:0xf bank_mask:0xf
    v_mov_b32_dpp v114, v138 row_newbcast:9 row_mask:0xf bank_mask:0xf
    v_mov_b32_dpp v87, v139 row_newbcast:1 row_mask:0xf bank_mask:0xf
    v_mov_b32_dpp v115, v139 row_newbcast:9 row_mask:0xf bank_mask:0xf
    v_mov_b32_dpp v88, v136 row_newbcast:2 row_mask:0xf bank_mask:0xf
    v_mov_b32_dpp v116, v136 row_newbcast:10 row_mask:0xf bank_mask:0xf
    v_mov_b32_dpp v89, v137 row_newbcast:2 row_mask:0xf bank_mask:0xf
    v_mov_b32_dpp v117, v137 row_newbcast:10 row_mask:0xf bank_mask:0xf
    v_mov_b32_dpp v90, v138 row_newbcast:2 row_mask:0xf bank_mask:0xf
    v_mov_b32_dpp v118, v138 row_newbcast:10 row_mask:0xf bank_mask:0xf
    v_mov_b32_dpp v91, v139 row_newbcast:2 row_mask:0xf bank_mask:0xf
    v_mov_b32_dpp v119, v139 row_newbcast:10 row_mask:0xf bank_mask:0xf
    v_mov_b32_dpp v92, v136 row_newbcast:3 row_mask:0xf bank_mask:0xf
    v_mov_b32_dpp v120, v136 row_newbcast:11 row_mask:0xf bank_mask:0xf
    v_mov_b32_dpp v93, v137 row_newbcast:3 row_mask:0xf bank_mask:0xf
    v_mov_b32_dpp v121, v137 row_newbcast:11 row_mask:0xf bank_mask:0xf
    v_mov_b32_dpp v94, v138 row_newbcast:3 row_mask:0xf bank_mask:0xf
    v_mov_b32_dpp v122, v138 row_newbcast:11 row_mask:0xf bank_mask:0xf
    v_mov_b32_dpp v95, v139 row_newbcast:3 row_mask:0xf bank_mask:0xf
    v_mov_b32_dpp v123, v139 row_newbcast:11 row_mask:0xf bank_mask:0xf
    v_mov_b32_dpp v96, v136 row_newbcast:4 row_mask:0xf bank_mask:0xf
    v_mov_b32_dpp v124, v136 row_newbcast:12 row_mask:0xf bank_mask:0xf
    v_mov_b32_dpp v97, v137 row_newbcast:4 row_mask:0xf bank_mask:0xf
    v_mov_b32_dpp v125, v137 row_newbcast:12 row_mask:0xf bank_mask:0xf
    v_mov_b32_dpp v98, v138 row_newbcast:4 row_mask:0xf bank_mask:0xf
    v_mov_b32_dpp v126, v138 row_newbcast:12 row_mask:0xf bank_mask:0xf
    v_mov_b32_dpp v99, v139 row_newbcast:4 row_mask:0xf bank_mask:0xf
    v_mov_b32_dpp v127, v139 row_newbcast:12 row_mask:0xf bank_mask:0xf
    v_mov_b32_dpp v100, v136 row_newbcast:5 row_mask:0xf bank_mask:0xf
    v_mov_b32_dpp v128, v136 row_newbcast:13 row_mask:0xf bank_mask:0xf
    v_mov_b32_dpp v101, v137 row_newbcast:5 row_mask:0xf bank_mask:0xf
    v_mov_b32_dpp v129, v137 row_newbcast:13 row_mask:0xf bank_mask:0xf
    v_mov_b32_dpp v102, v138 row_newbcast:5 row_mask:0xf bank_mask:0xf
    v_mov_b32_dpp v130, v138 row_newbcast:13 row_mask:0xf bank_mask:0xf
    v_mov_b32_dpp v103, v139 row_newbcast:5 row_mask:0xf bank_mask:0xf
    v_mov_b32_dpp v131, v139 row_newbcast:13 row_mask:0xf bank_mask:0xf
    v_mov_b32_dpp v104, v136 row_newbcast:6 row_mask:0xf bank_mask:0xf
    v_mov_b32_dpp v132, v136 row_newbcast:14 row_mask:0xf bank_mask:0xf
    v_mov_b32_dpp v105, v137 row_newbcast:6 row_mask:0xf bank_mask:0xf
    v_mov_b32_dpp v133, v137 row_newbcast:14 row_mask:0xf bank_mask:0xf
    v_mov_b32_dpp v106, v138 row_newbcast:6 row_mask:0xf bank_mask:0xf
    v_mov_b32_dpp v134, v138 row_newbcast:14 row_mask:0xf bank_mask:0xf
    v_mov_b32_dpp v107, v139 row_newbcast:6 row_mask:0xf bank_mask:0xf
    v_mov_b32_dpp v135, v139 row_newbcast:14 row_mask:0xf bank_mask:0xf
    s_lshr_b32 s69, s5, 4
    s_lshl_b32 s69, s69, 14
    s_lshl_b32 s61, s4, 7
    s_add_u32 s69, s69, s61
    s_add_u32 s61, s69, s65
    s_lshr_b32 s62, s3, 1
    s_lshl_b32 s62, s62, 13
    s_add_u32 s61, s61, s62
    s_and_b32 s62, s3, 1
    s_lshl_b32 s62, s62, 6
    s_add_u32 s61, s61, s62
    v_lshrrev_b32 v5, 1, v0
    v_lshlrev_b32 v5, 10, v5
    v_and_b32 v6, 1, v0
    v_lshl_add_u32 v5, v6, 5, v5
    s_mov_b32 exec_lo, 0xffff
    s_mov_b32 exec_hi, 0
    s_mov_b32 s62, 0
L_poll_20:
    buffer_load_dword v6, v5, s[8:11], s61 offen sc1
    s_add_u32 s62, s62, 1
    s_cmp_gt_u32 s62, s58
    s_cbranch_scc1 L_to_22
    s_waitcnt vmcnt(0)
    v_cmp_ne_u32 vcc, s6, v6
    s_cmp_eq_u64 vcc, 0
    s_cbranch_scc0 L_poll_20
    s_branch L_ok_21
L_to_22:
    s_mov_b32 s58, 0
    s_waitcnt vmcnt(0)
L_ok_21:
    s_mov_b64 exec, -1
    s_or_b32 s61, s2, s57
    s_or_b32 s61, s61, s3
    s_cmp_eq_u32 s61, 0
    s_cbranch_scc0 L_noep_23
    v_mov_b32 v5, s6
    s_mov_b64 exec, 1
    buffer_store_dword v5, off, s[8:11], 0 sc1
    s_mov_b64 exec, -1
L_noep_23:
    s_lshl_b32 s61, s53, 3
    s_lshl_b32 s62, s3, 1
    s_add_u32 s61, s61, s62
    s_lshl_b32 s61, s61, 14
    s_lshl_b32 s62, s57, 31
    s_and_b32 s62, s62, 0x7fffffff
    s_add_u32 s61, s61, s62
    s_add_u32 s66, s61, 5242880
    s_add_u32 s67, s66, 16384
    buffer_load_dwordx4 v[16:19], v1, s[8:11], s66 offen offset:0 sc1
    buffer_load_dwordx4 v[20:23], v1, s[8:11], s67 offen offset:0 sc1
    s_cmp_eq_u32 s57, 0
    s_cbranch_scc0 L_r0_24
    s_waitcnt vmcnt(2)
    ds_read_b64_tr_b16 a[96:97], v236 offset:0
    ds_read_b64_tr_b16 a[98:99], v236 offset:2048
    ds_read_b64_tr_b16 a[100:101], v237 offset:0
    ds_read_b64_tr_b16 a[102:103], v237 offset:2048
    ds_read_b64_tr_b16 a[104:105], v238 offset:0
    ds_read_b64_tr_b16 a[106:107], v238 offset:2048
    ds_read_b64_tr_b16 a[108:109], v239 offset:0
    ds_read_b64_tr_b16 a[110:111], v239 offset:2048
    s_waitcnt lgkmcnt(6)
    ds_read_b64_tr_b16 a[112:113], v236 offset:4096
    ds_read_b64_tr_b16 a[114:115], v236 offset:6144
    ds_read_b64_tr_b16 a[116:117], v237 offset:4096
    ds_read_b64_tr_b16 a[118:119], v237 offset:6144
    ds_read_b64_tr_b16 a[120:121], v238 offset:4096
    ds_read_b64_tr_b16 a[122:123], v238 offset:6144
    ds_read_b64_tr_b16 a[124:125], v239 offset:4096
    ds_read_b64_tr_b16 a[126:127], v239 offset:6144
    s_waitcnt lgkmcnt(6)
    ds_read_b64_tr_b16 a[128:129], v236 offset:8192
    ds_read_b64_tr_b16 a[130:131], v236 offset:10240
    ds_read_b64_tr_b16 a[132:133], v237 offset:8192
    ds_read_b64_tr_b16 a[134:135], v237 offset:10240
    ds_read_b64_tr_b16 a[136:137], v238 offset:8192
    ds_read_b64_tr_b16 a[138:139], v238 offset:10240
    ds_read_b64_tr_b16 a[140:141], v239 offset:8192
    ds_read_b64_tr_b16 a[142:143], v239 offset:10240
    s_waitcnt lgkmcnt(6)
    s_waitcnt lgkmcnt(0)
L_r0_24:
    s_lshl_b32 s61, s53, 1
    s_lshr_b32 s62, s3, 1
    s_add_u32 s61, s61, s62
    s_lshl_b32 s61, s61, 12
    s_and_b32 s62, s3, 1
    s_lshl_b32 s62, s62, 8
    s_add_u32 s61, s61, s62
    s_lshl_b32 s62, s57, 18
    s_add_u32 s61, s61, s62
    s_add_u32 s70, s61, 4587520
    s_add_u32 s71, s70, 128
    v_lshrrev_b32 v6, 2, v3
    v_lshl_add_u32 v6, v4, 2, v6
    v_mul_u32_u24 v6, 224, v6
    v_and_b32 v7, 3, v3
    v_lshl_add_u32 v6, v7, 3, v6
    v_add_u32 v7, 57344, v6
    v_mov_b32 v12, 0x3f317218
    v_mov_b32 v13, 0x3f317218
    s_mov_b32 s76, 2.0
    s_mov_b32 s77, 2.0
    s_mov_b32 s78, 0xbfb17218
    s_mov_b32 s79, 0xbfb17218
    v_lshlrev_b32 v14, 1, v4
    v_and_b32 v15, 7, v0
    v_xor_b32 v15, v15, v14
    v_lshrrev_b32 v14, 3, v0
    v_lshlrev_b32 v14, 10, v14
    v_lshl_add_u32 v14, v15, 4, v14
    v_lshrrev_b32 v15, 5, v0
    v_lshlrev_b32 v15, 12, v15
    v_add_u32 v15, v15, v14
    ds_read_b64_tr_b16 v[144:145], v6 offset:0
    ds_read_b64_tr_b16 v[146:147], v6 offset:3584
    ds_read_b64_tr_b16 v[148:149], v6 offset:32
    ds_read_b64_tr_b16 v[150:151], v6 offset:3616
    ds_read_b64_tr_b16 v[152:153], v6 offset:64
    ds_read_b64_tr_b16 v[154:155], v6 offset:3648
    ds_read_b64_tr_b16 v[156:157], v6 offset:96
    ds_read_b64_tr_b16 v[158:159], v6 offset:3680
    ds_read_b64_tr_b16 v[160:161], v6 offset:128
    ds_read_b64_tr_b16 v[162:163], v6 offset:3712
    ds_read_b64_tr_b16 v[164:165], v6 offset:160
    ds_read_b64_tr_b16 v[166:167], v6 offset:3744
    ds_read_b64_tr_b16 v[168:169], v6 offset:192
    ds_read_b64_tr_b16 v[170:171], v6 offset:3776
    s_waitcnt vmcnt(0)
    s_waitcnt lgkmcnt(12)
    v_mfma_f32_16x16x32_bf16 v[200:203], v[144:147], v[16:19], 0
    v_mfma_f32_16x16x32_bf16 v[204:207], v[144:147], v[20:23], 0
    ds_read_b64_tr_b16 v[172:173], v6 offset:7168
    ds_read_b64_tr_b16 v[174:175], v6 offset:10752
    s_waitcnt lgkmcnt(12)
    v_mfma_f32_16x16x32_bf16 v[208:211], v[148:151], v[16:19], 0
    v_mfma_f32_16x16x32_bf16 v[212:215], v[148:151], v[20:23], 0
    ds_read_b64_tr_b16 v[176:177], v6 offset:7200
    ds_read_b64_tr_b16 v[178:179], v6 offset:10784
    buffer_load_dwordx4 v[24:27], v1, s[8:11], s66 offen offset:1024 sc1
    buffer_load_dwordx4 v[28:31], v1, s[8:11], s67 offen offset:1024 sc1
    s_waitcnt lgkmcnt(12)
    v_mfma_f32_16x16x32_bf16 v[216:219], v[152:155], v[16:19], 0
    v_mfma_f32_16x16x32_bf16 v[220:223], v[152:155], v[20:23], 0
    ds_read_b64_tr_b16 v[180:181], v6 offset:7232
    ds_read_b64_tr_b16 v[182:183], v6 offset:10816
    s_waitcnt lgkmcnt(12)
    v_mfma_f32_16x16x32_bf16 v[224:227], v[156:159], v[16:19], 0
    v_mfma_f32_16x16x32_bf16 v[228:231], v[156:159], v[20:23], 0
    ds_read_b64_tr_b16 v[184:185], v6 offset:7264
    ds_read_b64_tr_b16 v[186:187], v6 offset:10848
    s_waitcnt lgkmcnt(12)
    v_mfma_f32_16x16x32_bf16 v[232:235], v[160:163], v[16:19], 0
    v_mfma_f32_16x16x32_bf16 v[236:239], v[160:163], v[20:23], 0
    ds_read_b64_tr_b16 v[188:189], v6 offset:7296
    ds_read_b64_tr_b16 v[190:191], v6 offset:10880
    buffer_load_dwordx4 v[32:35], v1, s[8:11], s66 offen offset:2048 sc1
    buffer_load_dwordx4 v[36:39], v1, s[8:11], s67 offen offset:2048 sc1
    s_waitcnt lgkmcnt(12)
    v_mfma_f32_16x16x32_bf16 v[240:243], v[164:167], v[16:19], 0
    v_mfma_f32_16x16x32_bf16 v[244:247], v[164:167], v[20:23], 0
    ds_read_b64_tr_b16 v[192:193], v6 offset:7328
    ds_read_b64_tr_b16 v[194:195], v6 offset:10912
    s_waitcnt lgkmcnt(12)
    v_mfma_f32_16x16x32_bf16 v[248:251], v[168:171], v[16:19], 0
    v_mfma_f32_16x16x32_bf16 v[252:255], v[168:171], v[20:23], 0
    ds_read_b64_tr_b16 v[196:197], v6 offset:7360
    ds_read_b64_tr_b16 v[198:199], v6 offset:10944
    s_waitcnt vmcnt(2)
    s_waitcnt lgkmcnt(12)
    v_mfma_f32_16x16x32_bf16 v[200:203], v[172:175], v[24:27], v[200:203]
    v_mfma_f32_16x16x32_bf16 v[204:207], v[172:175], v[28:31], v[204:207]
    ds_read_b64_tr_b16 v[144:145], v6 offset:14336
    ds_read_b64_tr_b16 v[146:147], v6 offset:17920
    s_waitcnt lgkmcnt(12)
    v_mfma_f32_16x16x32_bf16 v[208:211], v[176:179], v[24:27], v[208:211]
    v_mfma_f32_16x16x32_bf16 v[212:215], v[176:179], v[28:31], v[212:215]
    ds_read_b64_tr_b16 v[148:149], v6 offset:14368
    ds_read_b64_tr_b16 v[150:151], v6 offset:17952
    buffer_load_dwordx4 v[40:43], v1, s[8:11], s66 offen offset:3072 sc1
    buffer_load_dwordx4 v[44:47], v1, s[8:11], s67 offen offset:3072 sc1
    s_waitcnt lgkmcnt(12)
    v_mfma_f32_16x16x32_bf16 v[216:219], v[180:183], v[24:27], v[216:219]
    v_mfma_f32_16x16x32_bf16 v[220:223], v[180:183], v[28:31], v[220:223]
    ds_read_b64_tr_b16 v[152:153], v6 offset:14400
    ds_read_b64_tr_b16 v[154:155], v6 offset:17984
    s_waitcnt lgkmcnt(12)
    v_mfma_f32_16x16x32_bf16 v[224:227], v[184:187], v[24:27], v[224:227]
    v_mfma_f32_16x16x32_bf16 v[228:231], v[184:187], v[28:31], v[228:231]
    ds_read_b64_tr_b16 v[156:157], v6 offset:14432
    ds_read_b64_tr_b16 v[158:159], v6 offset:18016
    s_waitcnt lgkmcnt(12)
    v_mfma_f32_16x16x32_bf16 v[232:235], v[188:191], v[24:27], v[232:235]
    v_mfma_f32_16x16x32_bf16 v[236:239], v[188:191], v[28:31], v[236:239]
    ds_read_b64_tr_b16 v[160:161], v6 offset:14464
    ds_read_b64_tr_b16 v[162:163], v6 offset:18048
    s_add_u32 s66, s66, 4096
    s_add_u32 s67, s67, 4096
    buffer_load_dwordx4 v[48:51], v1, s[8:11], s66 offen offset:0 sc1
    buffer_load_dwordx4 v[52:55], v1, s[8:11], s67 offen offset:0 sc1
    s_waitcnt lgkmcnt(12)
    v_mfma_f32_16x16x32_bf16 v[240:243], v[192:195], v[24:27], v[240:243]
    v_mfma_f32_16x16x32_bf16 v[244:247], v[192:195], v[28:31], v[244:247]
    ds_read_b64_tr_b16 v[164:165], v6 offset:14496
    ds_read_b64_tr_b16 v[166:167], v6 offset:18080
    s_waitcnt lgkmcnt(12)
    v_mfma_f32_16x16x32_bf16 v[248:251], v[196:199], v[24:27], v[248:251]
    v_mfma_f32_16x16x32_bf16 v[252:255], v[196:199], v[28:31], v[252:255]
    ds_read_b64_tr_b16 v[168:169], v6 offset:14528
    ds_read_b64_tr_b16 v[170:171], v6 offset:18112
    s_waitcnt vmcnt(4)
    s_waitcnt lgkmcnt(12)
    v_mfma_f32_16x16x32_bf16 v[200:203], v[144:147], v[32:35], v[200:203]
    v_mfma_f32_16x16x32_bf16 v[204:207], v[144:147], v[36:39], v[204:207]
    ds_read_b64_tr_b16 v[172:173], v6 offset:21504
    ds_read_b64_tr_b16 v[174:175], v6 offset:25088
    s_waitcnt lgkmcnt(12)
    v_mfma_f32_16x16x32_bf16 v[208:211], v[148:151], v[32:35], v[208:211]
    v_mfma_f32_16x16x32_bf16 v[212:215], v[148:151], v[36:39], v[212:215]
    ds_read_b64_tr_b16 v[176:177], v6 offset:21536
    ds_read_b64_tr_b16 v[178:179], v6 offset:25120
    buffer_load_dwordx4 v[56:59], v1, s[8:11], s66 offen offset:1024 sc1
    buffer_load_dwordx4 v[60:63], v1, s[8:11], s67 offen offset:1024 sc1
    s_waitcnt lgkmcnt(12)
    v_mfma_f32_16x16x32_bf16 v[216:219], v[152:155], v[32:35], v[216:219]
    v_mfma_f32_16x16x32_bf16 v[220:223], v[152:155], v[36:39], v[220:223]
    ds_read_b64_tr_b16 v[180:181], v6 offset:21568
    ds_read_b64_tr_b16 v[182:183], v6 offset:25152
    s_waitcnt lgkmcnt(12)
    v_mfma_f32_16x16x32_bf16 v[224:227], v[156:159], v[32:35], v[224:227]
    v_mfma_f32_16x16x32_bf16 v[228:231], v[156:159], v[36:39], v[228:231]
    ds_read_b64_tr_b16 v[184:185], v6 offset:21600
    ds_read_b64_tr_b16 v[186:187], v6 offset:25184
    s_cmp_eq_u32 s57, 0
    s_cbranch_scc0 L_r0_25
    s_add_u32 m0, s72, 0
    s_add_u32 s75, s74, 294912
    buffer_load_dwordx4 v14, s[32:35], s75 offen lds
    s_add_u32 m0, s72, 1024
    s_add_u32 s75, s74, 303104
    buffer_load_dwordx4 v14, s[32:35], s75 offen lds
L_r0_25:
    s_waitcnt lgkmcnt(12)
    v_mfma_f32_16x16x32_bf16 v[232:235], v[160:163], v[32:35], v[232:235]
    v_mfma_f32_16x16x32_bf16 v[236:239], v[160:163], v[36:39], v[236:239]
    ds_read_b64_tr_b16 v[188:189], v6 offset:21632
    ds_read_b64_tr_b16 v[190:191], v6 offset:25216
    buffer_load_dwordx4 v[64:67], v1, s[8:11], s66 offen offset:2048 sc1
    buffer_load_dwordx4 v[68:71], v1, s[8:11], s67 offen offset:2048 sc1
    s_waitcnt lgkmcnt(12)
    v_mfma_f32_16x16x32_bf16 v[240:243], v[164:167], v[32:35], v[240:243]
    v_mfma_f32_16x16x32_bf16 v[244:247], v[164:167], v[36:39], v[244:247]
    ds_read_b64_tr_b16 v[192:193], v6 offset:21664
    ds_read_b64_tr_b16 v[194:195], v6 offset:25248
    s_waitcnt lgkmcnt(12)
    v_mfma_f32_16x16x32_bf16 v[248:251], v[168:171], v[32:35], v[248:251]
    v_mfma_f32_16x16x32_bf16 v[252:255], v[168:171], v[36:39], v[252:255]
    ds_read_b64_tr_b16 v[196:197], v6 offset:21696
    ds_read_b64_tr_b16 v[198:199], v6 offset:25280
    s_waitcnt vmcnt(6)
    s_waitcnt lgkmcnt(12)
    v_mfma_f32_16x16x32_bf16 v[200:203], v[172:175], v[40:43], v[200:203]
    v_mfma_f32_16x16x32_bf16 v[204:207], v[172:175], v[44:47], v[204:207]
    ds_read_b64_tr_b16 v[144:145], v6 offset:28672
    ds_read_b64_tr_b16 v[146:147], v6 offset:32256
    s_waitcnt lgkmcnt(12)
    v_mfma_f32_16x16x32_bf16 v[208:211], v[176:179], v[40:43], v[208:211]
    v_mfma_f32_16x16x32_bf16 v[212:215], v[176:179], v[44:47], v[212:215]
    ds_read_b64_tr_b16 v[148:149], v6 offset:28704
    ds_read_b64_tr_b16 v[150:151], v6 offset:32288
    buffer_load_dwordx4 v[72:75], v1, s[8:11], s66 offen offset:3072 sc1
    buffer_load_dwordx4 v[76:79], v1, s[8:11], s67 offen offset:3072 sc1
    s_waitcnt lgkmcnt(12)
    v_mfma_f32_16x16x32_bf16 v[216:219], v[180:183], v[40:43], v[216:219]
    v_mfma_f32_16x16x32_bf16 v[220:223], v[180:183], v[44:47], v[220:223]
    ds_read_b64_tr_b16 v[152:153], v6 offset:28736
    ds_read_b64_tr_b16 v[154:155], v6 offset:32320
    s_waitcnt lgkmcnt(12)
    v_mfma_f32_16x16x32_bf16 v[224:227], v[184:187], v[40:43], v[224:227]
    v_mfma_f32_16x16x32_bf16 v[228:231], v[184:187], v[44:47], v[228:231]
    ds_read_b64_tr_b16 v[156:157], v6 offset:28768
    ds_read_b64_tr_b16 v[158:159], v6 offset:32352
    s_cmp_eq_u32 s57, 0
    s_cbranch_scc0 L_r0_26
    s_add_u32 m0, s72, 2048
    s_add_u32 s75, s74, 311296
    buffer_load_dwordx4 v14, s[32:35], s75 offen lds
    s_add_u32 m0, s72, 3072
    s_add_u32 s75, s74, 319488
    buffer_load_dwordx4 v14, s[32:35], s75 offen lds
L_r0_26:
    s_waitcnt lgkmcnt(12)
    v_mfma_f32_16x16x32_bf16 v[232:235], v[188:191], v[40:43], v[232:235]
    v_mfma_f32_16x16x32_bf16 v[236:239], v[188:191], v[44:47], v[236:239]
    ds_read_b64_tr_b16 v[160:161], v6 offset:28800
    ds_read_b64_tr_b16 v[162:163], v6 offset:32384
    s_add_u32 s66, s66, 4096
    s_add_u32 s67, s67, 4096
    buffer_load_dwordx4 v[16:19], v1, s[8:11], s66 offen offset:0 sc1
    buffer_load_dwordx4 v[20:23], v1, s[8:11], s67 offen offset:0 sc1
    s_waitcnt lgkmcnt(12)
    v_mfma_f32_16x16x32_bf16 v[240:243], v[192:195], v[40:43], v[240:243]
    v_mfma_f32_16x16x32_bf16 v[244:247], v[192:195], v[44:47], v[244:247]
    ds_read_b64_tr_b16 v[164:165], v6 offset:28832
    ds_read_b64_tr_b16 v[166:167], v6 offset:32416
    s_waitcnt lgkmcnt(12)
    v_mfma_f32_16x16x32_bf16 v[248:251], v[196:199], v[40:43], v[248:251]
    v_mfma_f32_16x16x32_bf16 v[252:255], v[196:199], v[44:47], v[252:255]
    ds_read_b64_tr_b16 v[168:169], v6 offset:28864
    ds_read_b64_tr_b16 v[170:171], v6 offset:32448
    s_waitcnt vmcnt(8)
    s_waitcnt lgkmcnt(12)
    v_mfma_f32_16x16x32_bf16 v[200:203], v[144:147], v[48:51], v[200:203]
    v_mfma_f32_16x16x32_bf16 v[204:207], v[144:147], v[52:55], v[204:207]
    ds_read_b64_tr_b16 v[172:173], v6 offset:35840
    ds_read_b64_tr_b16 v[174:175], v6 offset:39424
    s_waitcnt lgkmcnt(12)
    v_mfma_f32_16x16x32_bf16 v[208:211], v[148:151], v[48:51], v[208:211]
    v_mfma_f32_16x16x32_bf16 v[212:215], v[148:151], v[52:55], v[212:215]
    ds_read_b64_tr_b16 v[176:177], v6 offset:35872
    ds_read_b64_tr_b16 v[178:179], v6 offset:39456
    buffer_load_dwordx4 v[24:27], v1, s[8:11], s66 offen offset:1024 sc1
    buffer_load_dwordx4 v[28:31], v1, s[8:11], s67 offen offset:1024 sc1
    s_waitcnt lgkmcnt(12)
    v_mfma_f32_16x16x32_bf16 v[216:219], v[152:155], v[48:51], v[216:219]
    v_mfma_f32_16x16x32_bf16 v[220:223], v[152:155], v[52:55], v[220:223]
    ds_read_b64_tr_b16 v[180:181], v6 offset:35904
    ds_read_b64_tr_b16 v[182:183], v6 offset:39488
    s_waitcnt lgkmcnt(12)
    v_mfma_f32_16x16x32_bf16 v[224:227], v[156:159], v[48:51], v[224:227]
    v_mfma_f32_16x16x32_bf16 v[228:231], v[156:159], v[52:55], v[228:231]
    ds_read_b64_tr_b16 v[184:185], v6 offset:35936
    ds_read_b64_tr_b16 v[186:187], v6 offset:39520
    s_cmp_eq_u32 s57, 0
    s_cbranch_scc0 L_r0_27
    s_add_u32 m0, s72, 4096
    s_add_u32 s75, s74, 327680
    buffer_load_dwordx4 v15, s[32:35], s75 offen lds
    s_add_u32 m0, s72, 5120
    s_add_u32 s75, s74, 442368
    buffer_load_dwordx4 v15, s[32:35], s75 offen lds
L_r0_27:
    s_waitcnt lgkmcnt(12)
    v_mfma_f32_16x16x32_bf16 v[232:235], v[160:163], v[48:51], v[232:235]
    v_mfma_f32_16x16x32_bf16 v[236:239], v[160:163], v[52:55], v[236:239]
    ds_read_b64_tr_b16 v[188:189], v6 offset:35968
    ds_read_b64_tr_b16 v[190:191], v6 offset:39552
    buffer_load_dwordx4 v[32:35], v1, s[8:11], s66 offen offset:2048 sc1
    buffer_load_dwordx4 v[36:39], v1, s[8:11], s67 offen offset:2048 sc1
    s_waitcnt lgkmcnt(12)
    v_mfma_f32_16x16x32_bf16 v[240:243], v[164:167], v[48:51], v[240:243]
    v_mfma_f32_16x16x32_bf16 v[244:247], v[164:167], v[52:55], v[244:247]
    ds_read_b64_tr_b16 v[192:193], v6 offset:36000
    ds_read_b64_tr_b16 v[194:195], v6 offset:39584
    s_waitcnt lgkmcnt(12)
    v_mfma_f32_16x16x32_bf16 v[248:251], v[168:171], v[48:51], v[248:251]
    v_mfma_f32_16x16x32_bf16 v[252:255], v[168:171], v[52:55], v[252:255]
    ds_read_b64_tr_b16 v[196:197], v6 offset:36032
    ds_read_b64_tr_b16 v[198:199], v6 offset:39616
    s_waitcnt vmcnt(10)
    s_waitcnt lgkmcnt(12)
    v_mfma_f32_16x16x32_bf16 v[200:203], v[172:175], v[56:59], v[200:203]
    v_mfma_f32_16x16x32_bf16 v[204:207], v[172:175], v[60:63], v[204:207]
    ds_read_b64_tr_b16 v[144:145], v6 offset:43008
    ds_read_b64_tr_b16 v[146:147], v6 offset:46592
    s_waitcnt lgkmcnt(12)
    v_mfma_f32_16x16x32_bf16 v[208:211], v[176:179], v[56:59], v[208:211]
    v_mfma_f32_16x16x32_bf16 v[212:215], v[176:179], v[60:63], v[212:215]
    ds_read_b64_tr_b16 v[148:149], v6 offset:43040
    ds_read_b64_tr_b16 v[150:151], v6 offset:46624
    buffer_load_dwordx4 v[40:43], v1, s[8:11], s66 offen offset:3072 sc1
    buffer_load_dwordx4 v[44:47], v1, s[8:11], s67 offen offset:3072 sc1
    s_waitcnt lgkmcnt(12)
    v_mfma_f32_16x16x32_bf16 v[216:219], v[180:183], v[56:59], v[216:219]
    v_mfma_f32_16x16x32_bf16 v[220:223], v[180:183], v[60:63], v[220:223]
    ds_read_b64_tr_b16 v[152:153], v6 offset:43072
    ds_read_b64_tr_b16 v[154:155], v6 offset:46656
    s_waitcnt lgkmcnt(12)
    v_mfma_f32_16x16x32_bf16 v[224:227], v[184:187], v[56:59], v[224:227]
    v_mfma_f32_16x16x32_bf16 v[228:231], v[184:187], v[60:63], v[228:231]
    ds_read_b64_tr_b16 v[156:157], v6 offset:43104
    ds_read_b64_tr_b16 v[158:159], v6 offset:46688
    s_cmp_eq_u32 s57, 0
    s_cbranch_scc0 L_r0_28
    s_add_u32 m0, s72, 6144
    s_add_u32 s75, s74, 331776
    buffer_load_dwordx4 v15, s[32:35], s75 offen lds
    s_add_u32 m0, s72, 7168
    s_add_u32 s75, s74, 446464
    buffer_load_dwordx4 v15, s[32:35], s75 offen lds
L_r0_28:
    s_waitcnt lgkmcnt(12)
    v_mfma_f32_16x16x32_bf16 v[232:235], v[188:191], v[56:59], v[232:235]
    v_mfma_f32_16x16x32_bf16 v[236:239], v[188:191], v[60:63], v[236:239]
    ds_read_b64_tr_b16 v[160:161], v6 offset:43136
    ds_read_b64_tr_b16 v[162:163], v6 offset:46720
    s_waitcnt lgkmcnt(12)
    v_mfma_f32_16x16x32_bf16 v[240:243], v[192:195], v[56:59], v[240:243]
    v_mfma_f32_16x16x32_bf16 v[244:247], v[192:195], v[60:63], v[244:247]
    ds_read_b64_tr_b16 v[164:165], v6 offset:43168
    ds_read_b64_tr_b16 v[166:167], v6 offset:46752
    v_lshlrev_b32 v9, 3, v3
    v_lshl_add_u32 v9, v4, 10, v9
    buffer_load_dwordx2 v[136:137], v9, s[8:11], s70 offen sc1
    buffer_load_dwordx2 v[138:139], v9, s[8:11], s70 offen offset:512 sc1
    buffer_load_dwordx2 v[140:141], v9, s[8:11], s71 offen sc1
    buffer_load_dwordx2 v[142:143], v9, s[8:11], s71 offen offset:512 sc1
    s_waitcnt lgkmcnt(12)
    v_mfma_f32_16x16x32_bf16 v[248:251], v[196:199], v[56:59], v[248:251]
    v_mfma_f32_16x16x32_bf16 v[252:255], v[196:199], v[60:63], v[252:255]
    ds_read_b64_tr_b16 v[168:169], v6 offset:43200
    ds_read_b64_tr_b16 v[170:171], v6 offset:46784
    s_waitcnt vmcnt(14)
    s_waitcnt lgkmcnt(12)
    v_mfma_f32_16x16x32_bf16 v[200:203], v[144:147], v[64:67], v[200:203]
    v_mfma_f32_16x16x32_bf16 v[204:207], v[144:147], v[68:71], v[204:207]
    ds_read_b64_tr_b16 v[172:173], v6 offset:50176
    ds_read_b64_tr_b16 v[174:175], v6 offset:53760
    s_waitcnt lgkmcnt(12)
    v_mfma_f32_16x16x32_bf16 v[208:211], v[148:151], v[64:67], v[208:211]
    v_mfma_f32_16x16x32_bf16 v[212:215], v[148:151], v[68:71], v[212:215]
    ds_read_b64_tr_b16 v[176:177], v6 offset:50208
    ds_read_b64_tr_b16 v[178:179], v6 offset:53792
    s_add_u32 s66, s66, 4096
    s_add_u32 s67, s67, 4096
    buffer_load_dwordx4 v[48:51], v1, s[8:11], s66 offen offset:0 sc1
    buffer_load_dwordx4 v[52:55], v1, s[8:11], s67 offen offset:0 sc1
    s_waitcnt lgkmcnt(12)
    v_mfma_f32_16x16x32_bf16 v[216:219], v[152:155], v[64:67], v[216:219]
    v_mfma_f32_16x16x32_bf16 v[220:223], v[152:155], v[68:71], v[220:223]
    ds_read_b64_tr_b16 v[180:181], v6 offset:50240
    ds_read_b64_tr_b16 v[182:183], v6 offset:53824
    s_waitcnt lgkmcnt(12)
    v_mfma_f32_16x16x32_bf16 v[224:227], v[156:159], v[64:67], v[224:227]
    v_mfma_f32_16x16x32_bf16 v[228:231], v[156:159], v[68:71], v[228:231]
    ds_read_b64_tr_b16 v[184:185], v6 offset:50272
    ds_read_b64_tr_b16 v[186:187], v6 offset:53856
    s_cmp_eq_u32 s57, 0
    s_cbranch_scc0 L_r0_29
    s_add_u32 m0, s72, 8192
    s_add_u32 s75, s74, 344064
    buffer_load_dwordx4 v14, s[32:35], s75 offen lds
    s_add_u32 m0, s72, 9216
    s_add_u32 s75, s74, 352256
    buffer_load_dwordx4 v14, s[32:35], s75 offen lds
L_r0_29:
    s_waitcnt lgkmcnt(12)
    v_mfma_f32_16x16x32_bf16 v[232:235], v[160:163], v[64:67], v[232:235]
    v_mfma_f32_16x16x32_bf16 v[236:239], v[160:163], v[68:71], v[236:239]
    ds_read_b64_tr_b16 v[188:189], v6 offset:50304
    ds_read_b64_tr_b16 v[190:191], v6 offset:53888
    s_waitcnt lgkmcnt(12)
    v_mfma_f32_16x16x32_bf16 v[240:243], v[164:167], v[64:67], v[240:243]
    v_mfma_f32_16x16x32_bf16 v[244:247], v[164:167], v[68:71], v[244:247]
    ds_read_b64_tr_b16 v[192:193], v6 offset:50336
    ds_read_b64_tr_b16 v[194:195], v6 offset:53920
    s_waitcnt lgkmcnt(12)
    v_mfma_f32_16x16x32_bf16 v[248:251], v[168:171], v[64:67], v[248:251]
    v_mfma_f32_16x16x32_bf16 v[252:255], v[168:171], v[68:71], v[252:255]
    ds_read_b64_tr_b16 v[196:197], v6 offset:50368
    ds_read_b64_tr_b16 v[198:199], v6 offset:53952
    s_waitcnt vmcnt(14)
    s_waitcnt lgkmcnt(12)
    v_mfma_f32_16x16x32_bf16 v[200:203], v[172:175], v[72:75], v[200:203]
    v_mfma_f32_16x16x32_bf16 v[204:207], v[172:175], v[76:79], v[204:207]
    ds_read_b64_tr_b16 v[144:145], v7 offset:0
    ds_read_b64_tr_b16 v[146:147], v7 offset:3584
    s_waitcnt lgkmcnt(12)
    v_mfma_f32_16x16x32_bf16 v[208:211], v[176:179], v[72:75], v[208:211]
    v_mfma_f32_16x16x32_bf16 v[212:215], v[176:179], v[76:79], v[212:215]
    ds_read_b64_tr_b16 v[148:149], v7 offset:32
    ds_read_b64_tr_b16 v[150:151], v7 offset:3616
    buffer_load_dwordx4 v[56:59], v1, s[8:11], s66 offen offset:1024 sc1
    buffer_load_dwordx4 v[60:63], v1, s[8:11], s67 offen offset:1024 sc1
    s_waitcnt lgkmcnt(12)
    v_mfma_f32_16x16x32_bf16 v[216:219], v[180:183], v[72:75], v[216:219]
    v_mfma_f32_16x16x32_bf16 v[220:223], v[180:183], v[76:79], v[220:223]
    ds_read_b64_tr_b16 v[152:153], v7 offset:64
    ds_read_b64_tr_b16 v[154:155], v7 offset:3648
    s_waitcnt lgkmcnt(12)
    v_mfma_f32_16x16x32_bf16 v[224:227], v[184:187], v[72:75], v[224:227]
    v_mfma_f32_16x16x32_bf16 v[228:231], v[184:187], v[76:79], v[228:231]
    ds_read_b64_tr_b16 v[156:157], v7 offset:96
    ds_read_b64_tr_b16 v[158:159], v7 offset:3680
    s_cmp_eq_u32 s57, 0
    s_cbranch_scc0 L_r0_30
    s_add_u32 m0, s72, 10240
    s_add_u32 s75, s74, 360448
    buffer_load_dwordx4 v14, s[32:35], s75 offen lds
    s_add_u32 m0, s72, 11264
    s_add_u32 s75, s74, 368640
    buffer_load_dwordx4 v14, s[32:35], s75 offen lds
L_r0_30:
    s_waitcnt lgkmcnt(12)
    v_mfma_f32_16x16x32_bf16 v[232:235], v[188:191], v[72:75], v[232:235]
    v_mfma_f32_16x16x32_bf16 v[236:239], v[188:191], v[76:79], v[236:239]
    ds_read_b64_tr_b16 v[160:161], v7 offset:128
    ds_read_b64_tr_b16 v[162:163], v7 offset:3712
    s_waitcnt lgkmcnt(12)
    v_mfma_f32_16x16x32_bf16 v[240:243], v[192:195], v[72:75], v[240:243]
    v_mfma_f32_16x16x32_bf16 v[244:247], v[192:195], v[76:79], v[244:247]
    ds_read_b64_tr_b16 v[164:165], v7 offset:160
    ds_read_b64_tr_b16 v[166:167], v7 offset:3744
    s_waitcnt lgkmcnt(12)
    v_mfma_f32_16x16x32_bf16 v[248:251], v[196:199], v[72:75], v[248:251]
    v_mfma_f32_16x16x32_bf16 v[252:255], v[196:199], v[76:79], v[252:255]
    ds_read_b64_tr_b16 v[168:169], v7 offset:192
    ds_read_b64_tr_b16 v[170:171], v7 offset:3776
    s_waitcnt vmcnt(14)
    s_waitcnt lgkmcnt(12)
    v_mfma_f32_16x16x32_bf16 v[200:203], v[144:147], v[16:19], v[200:203]
    v_mfma_f32_16x16x32_bf16 v[204:207], v[144:147], v[20:23], v[204:207]
    ds_read_b64_tr_b16 v[172:173], v7 offset:7168
    ds_read_b64_tr_b16 v[174:175], v7 offset:10752
    s_waitcnt lgkmcnt(12)
    v_mfma_f32_16x16x32_bf16 v[208:211], v[148:151], v[16:19], v[208:211]
    v_mfma_f32_16x16x32_bf16 v[212:215], v[148:151], v[20:23], v[212:215]
    ds_read_b64_tr_b16 v[176:177], v7 offset:7200
    ds_read_b64_tr_b16 v[178:179], v7 offset:10784
    buffer_load_dwordx4 v[64:67], v1, s[8:11], s66 offen offset:2048 sc1
    buffer_load_dwordx4 v[68:71], v1, s[8:11], s67 offen offset:2048 sc1
    s_waitcnt lgkmcnt(12)
    v_mfma_f32_16x16x32_bf16 v[216:219], v[152:155], v[16:19], v[216:219]
    v_mfma_f32_16x16x32_bf16 v[220:223], v[152:155], v[20:23], v[220:223]
    ds_read_b64_tr_b16 v[180:181], v7 offset:7232
    ds_read_b64_tr_b16 v[182:183], v7 offset:10816
    s_waitcnt lgkmcnt(12)
    v_mfma_f32_16x16x32_bf16 v[224:227], v[156:159], v[16:19], v[224:227]
    v_mfma_f32_16x16x32_bf16 v[228:231], v[156:159], v[20:23], v[228:231]
    ds_read_b64_tr_b16 v[184:185], v7 offset:7264
    ds_read_b64_tr_b16 v[186:187], v7 offset:10848
    s_waitcnt lgkmcnt(12)
    v_mfma_f32_16x16x32_bf16 v[232:235], v[160:163], v[16:19], v[232:235]
    v_mfma_f32_16x16x32_bf16 v[236:239], v[160:163], v[20:23], v[236:239]
    ds_read_b64_tr_b16 v[188:189], v7 offset:7296
    ds_read_b64_tr_b16 v[190:191], v7 offset:10880
    s_waitcnt lgkmcnt(12)
    v_mfma_f32_16x16x32_bf16 v[240:243], v[164:167], v[16:19], v[240:243]
    v_mfma_f32_16x16x32_bf16 v[244:247], v[164:167], v[20:23], v[244:247]
    ds_read_b64_tr_b16 v[192:193], v7 offset:7328
    ds_read_b64_tr_b16 v[194:195], v7 offset:10912
    s_waitcnt lgkmcnt(12)
    v_mfma_f32_16x16x32_bf16 v[248:251], v[168:171], v[16:19], v[248:251]
    v_mfma_f32_16x16x32_bf16 v[252:255], v[168:171], v[20:23], v[252:255]
    ds_read_b64_tr_b16 v[196:197], v7 offset:7360
    ds_read_b64_tr_b16 v[198:199], v7 offset:10944
    s_waitcnt vmcnt(14)
    s_waitcnt lgkmcnt(12)
    v_mfma_f32_16x16x32_bf16 v[200:203], v[172:175], v[24:27], v[200:203]
    v_mfma_f32_16x16x32_bf16 v[204:207], v[172:175], v[28:31], v[204:207]
    ds_read_b64_tr_b16 v[144:145], v7 offset:14336
    ds_read_b64_tr_b16 v[146:147], v7 offset:17920
    s_waitcnt lgkmcnt(12)
    v_mfma_f32_16x16x32_bf16 v[208:211], v[176:179], v[24:27], v[208:211]
    v_mfma_f32_16x16x32_bf16 v[212:215], v[176:179], v[28:31], v[212:215]
    ds_read_b64_tr_b16 v[148:149], v7 offset:14368
    ds_read_b64_tr_b16 v[150:151], v7 offset:17952
    buffer_load_dwordx4 v[72:75], v1, s[8:11], s66 offen offset:3072 sc1
    buffer_load_dwordx4 v[76:79], v1, s[8:11], s67 offen offset:3072 sc1
    s_waitcnt lgkmcnt(12)
    v_mfma_f32_16x16x32_bf16 v[216:219], v[180:183], v[24:27], v[216:219]
    v_mfma_f32_16x16x32_bf16 v[220:223], v[180:183], v[28:31], v[220:223]
    ds_read_b64_tr_b16 v[152:153], v7 offset:14400
    ds_read_b64_tr_b16 v[154:155], v7 offset:17984
    s_waitcnt lgkmcnt(12)
    v_mfma_f32_16x16x32_bf16 v[224:227], v[184:187], v[24:27], v[224:227]
    v_mfma_f32_16x16x32_bf16 v[228:231], v[184:187], v[28:31], v[228:231]
    ds_read_b64_tr_b16 v[156:157], v7 offset:14432
    ds_read_b64_tr_b16 v[158:159], v7 offset:18016
    s_waitcnt lgkmcnt(12)
    v_mfma_f32_16x16x32_bf16 v[232:235], v[188:191], v[24:27], v[232:235]
    v_mfma_f32_16x16x32_bf16 v[236:239], v[188:191], v[28:31], v[236:239]
    ds_read_b64_tr_b16 v[160:161], v7 offset:14464
    ds_read_b64_tr_b16 v[162:163], v7 offset:18048
    s_waitcnt lgkmcnt(12)
    v_mfma_f32_16x16x32_bf16 v[240:243], v[192:195], v[24:27], v[240:243]
    v_mfma_f32_16x16x32_bf16 v[244:247], v[192:195], v[28:31], v[244:247]
    ds_read_b64_tr_b16 v[164:165], v7 offset:14496
    ds_read_b64_tr_b16 v[166:167], v7 offset:18080
    s_waitcnt lgkmcnt(12)
    v_mfma_f32_16x16x32_bf16 v[248:251], v[196:199], v[24:27], v[248:251]
    v_mfma_f32_16x16x32_bf16 v[252:255], v[196:199], v[28:31], v[252:255]
    ds_read_b64_tr_b16 v[168:169], v7 offset:14528
    ds_read_b64_tr_b16 v[170:171], v7 offset:18112
    s_waitcnt vmcnt(14)
    s_waitcnt lgkmcnt(12)
    v_mfma_f32_16x16x32_bf16 v[200:203], v[144:147], v[32:35], v[200:203]
    v_mfma_f32_16x16x32_bf16 v[204:207], v[144:147], v[36:39], v[204:207]
    ds_read_b64_tr_b16 v[172:173], v7 offset:21504
    ds_read_b64_tr_b16 v[174:175], v7 offset:25088
    s_waitcnt lgkmcnt(12)
    v_mfma_f32_16x16x32_bf16 v[208:211], v[148:151], v[32:35], v[208:211]
    v_mfma_f32_16x16x32_bf16 v[212:215], v[148:151], v[36:39], v[212:215]
    ds_read_b64_tr_b16 v[176:177], v7 offset:21536
    ds_read_b64_tr_b16 v[178:179], v7 offset:25120
    s_waitcnt lgkmcnt(12)
    v_mfma_f32_16x16x32_bf16 v[216:219], v[152:155], v[32:35], v[216:219]
    v_mfma_f32_16x16x32_bf16 v[220:223], v[152:155], v[36:39], v[220:223]
    ds_read_b64_tr_b16 v[180:181], v7 offset:21568
    ds_read_b64_tr_b16 v[182:183], v7 offset:25152
    s_waitcnt lgkmcnt(12)
    v_mfma_f32_16x16x32_bf16 v[224:227], v[156:159], v[32:35], v[224:227]
    v_mfma_f32_16x16x32_bf16 v[228:231], v[156:159], v[36:39], v[228:231]
    ds_read_b64_tr_b16 v[184:185], v7 offset:21600
    ds_read_b64_tr_b16 v[186:187], v7 offset:25184
    s_waitcnt lgkmcnt(12)
    v_mfma_f32_16x16x32_bf16 v[232:235], v[160:163], v[32:35], v[232:235]
    v_mfma_f32_16x16x32_bf16 v[236:239], v[160:163], v[36:39], v[236:239]
    ds_read_b64_tr_b16 v[188:189], v7 offset:21632
    ds_read_b64_tr_b16 v[190:191], v7 offset:25216
    s_waitcnt lgkmcnt(12)
    v_mfma_f32_16x16x32_bf16 v[240:243], v[164:167], v[32:35], v[240:243]
    v_mfma_f32_16x16x32_bf16 v[244:247], v[164:167], v[36:39], v[244:247]
    ds_read_b64_tr_b16 v[192:193], v7 offset:21664
    ds_read_b64_tr_b16 v[194:195], v7 offset:25248
    s_waitcnt lgkmcnt(12)
    v_mfma_f32_16x16x32_bf16 v[248:251], v[168:171], v[32:35], v[248:251]
    v_mfma_f32_16x16x32_bf16 v[252:255], v[168:171], v[36:39], v[252:255]
    ds_read_b64_tr_b16 v[196:197], v7 offset:21696
    ds_read_b64_tr_b16 v[198:199], v7 offset:25280
    s_waitcnt vmcnt(12)
    s_waitcnt lgkmcnt(12)
    v_mfma_f32_16x16x32_bf16 v[200:203], v[172:175], v[40:43], v[200:203]
    v_mfma_f32_16x16x32_bf16 v[204:207], v[172:175], v[44:47], v[204:207]
    ds_read_b64_tr_b16 v[144:145], v7 offset:28672
    ds_read_b64_tr_b16 v[146:147], v7 offset:32256
    s_waitcnt lgkmcnt(12)
    v_mfma_f32_16x16x32_bf16 v[208:211], v[176:179], v[40:43], v[208:211]
    v_mfma_f32_16x16x32_bf16 v[212:215], v[176:179], v[44:47], v[212:215]
    ds_read_b64_tr_b16 v[148:149], v7 offset:28704
    ds_read_b64_tr_b16 v[150:151], v7 offset:32288
    s_waitcnt lgkmcnt(12)
    v_mfma_f32_16x16x32_bf16 v[216:219], v[180:183], v[40:43], v[216:219]
    v_mfma_f32_16x16x32_bf16 v[220:223], v[180:183], v[44:47], v[220:223]
    ds_read_b64_tr_b16 v[152:153], v7 offset:28736
    ds_read_b64_tr_b16 v[154:155], v7 offset:32320
    s_waitcnt lgkmcnt(12)
    v_mfma_f32_16x16x32_bf16 v[224:227], v[184:187], v[40:43], v[224:227]
    v_mfma_f32_16x16x32_bf16 v[228:231], v[184:187], v[44:47], v[228:231]
    ds_read_b64_tr_b16 v[156:157], v7 offset:28768
    ds_read_b64_tr_b16 v[158:159], v7 offset:32352
    s_waitcnt lgkmcnt(12)
    v_mfma_f32_16x16x32_bf16 v[232:235], v[188:191], v[40:43], v[232:235]
    v_mfma_f32_16x16x32_bf16 v[236:239], v[188:191], v[44:47], v[236:239]
    ds_read_b64_tr_b16 v[160:161], v7 offset:28800
    ds_read_b64_tr_b16 v[162:163], v7 offset:32384
    s_waitcnt lgkmcnt(12)
    v_mfma_f32_16x16x32_bf16 v[240:243], v[192:195], v[40:43], v[240:243]
    v_mfma_f32_16x16x32_bf16 v[244:247], v[192:195], v[44:47], v[244:247]
    ds_read_b64_tr_b16 v[164:165], v7 offset:28832
    ds_read_b64_tr_b16 v[166:167], v7 offset:32416
    s_waitcnt lgkmcnt(12)
    v_mfma_f32_16x16x32_bf16 v[248:251], v[196:199], v[40:43], v[248:251]
    v_mfma_f32_16x16x32_bf16 v[252:255], v[196:199], v[44:47], v[252:255]
    ds_read_b64_tr_b16 v[168:169], v7 offset:28864
    ds_read_b64_tr_b16 v[170:171], v7 offset:32448
    s_waitcnt vmcnt(6)
    s_waitcnt lgkmcnt(12)
    v_mfma_f32_16x16x32_bf16 v[200:203], v[144:147], v[48:51], v[200:203]
    v_mfma_f32_16x16x32_bf16 v[204:207], v[144:147], v[52:55], v[204:207]
    ds_read_b64_tr_b16 v[172:173], v7 offset:35840
    ds_read_b64_tr_b16 v[174:175], v7 offset:39424
    s_waitcnt lgkmcnt(12)
    v_mfma_f32_16x16x32_bf16 v[208:211], v[148:151], v[48:51], v[208:211]
    v_mfma_f32_16x16x32_bf16 v[212:215], v[148:151], v[52:55], v[212:215]
    ds_read_b64_tr_b16 v[176:177], v7 offset:35872
    ds_read_b64_tr_b16 v[178:179], v7 offset:39456
    s_waitcnt lgkmcnt(12)
    v_mfma_f32_16x16x32_bf16 v[216:219], v[152:155], v[48:51], v[216:219]
    v_mfma_f32_16x16x32_bf16 v[220:223], v[152:155], v[52:55], v[220:223]
    ds_read_b64_tr_b16 v[180:181], v7 offset:35904
    ds_read_b64_tr_b16 v[182:183], v7 offset:39488
    s_waitcnt lgkmcnt(12)
    v_mfma_f32_16x16x32_bf16 v[224:227], v[156:159], v[48:51], v[224:227]
    v_mfma_f32_16x16x32_bf16 v[228:231], v[156:159], v[52:55], v[228:231]
    ds_read_b64_tr_b16 v[184:185], v7 offset:35936
    ds_read_b64_tr_b16 v[186:187], v7 offset:39520
    s_waitcnt lgkmcnt(12)
    v_mfma_f32_16x16x32_bf16 v[232:235], v[160:163], v[48:51], v[232:235]
    v_mfma_f32_16x16x32_bf16 v[236:239], v[160:163], v[52:55], v[236:239]
    ds_read_b64_tr_b16 v[188:189], v7 offset:35968
    ds_read_b64_tr_b16 v[190:191], v7 offset:39552
    s_waitcnt lgkmcnt(12)
    v_mfma_f32_16x16x32_bf16 v[240:243], v[164:167], v[48:51], v[240:243]
    v_mfma_f32_16x16x32_bf16 v[244:247], v[164:167], v[52:55], v[244:247]
    ds_read_b64_tr_b16 v[192:193], v7 offset:36000
    ds_read_b64_tr_b16 v[194:195], v7 offset:39584
    s_waitcnt lgkmcnt(12)
    v_mfma_f32_16x16x32_bf16 v[248:251], v[168:171], v[48:51], v[248:251]
    v_mfma_f32_16x16x32_bf16 v[252:255], v[168:171], v[52:55], v[252:255]
    ds_read_b64_tr_b16 v[196:197], v7 offset:36032
    ds_read_b64_tr_b16 v[198:199], v7 offset:39616
    v_pk_add_f32 v[136:137], v[136:137], v[138:139]
    v_mov_b32 v138, v136
    v_mov_b32 v139, v137
    s_nop 0
    v_permlane16_swap_b32 v136, v138
    v_permlane16_swap_b32 v137, v139
    v_pk_add_f32 v[136:137], v[136:137], v[138:139]
    v_mov_b32 v138, v136
    v_mov_b32 v139, v137
    s_nop 0
    v_permlane32_swap_b32 v136, v138
    v_permlane32_swap_b32 v137, v139
    v_pk_add_f32 v[136:137], v[136:137], v[138:139]
    v_mul_f32 v136, 0x3b000000, v136
    v_mul_f32 v137, 0x3b000000, v137
    v_fma_f32 v137, -v136, v136, v137
    v_max_f32 v137, 0, v137
    v_add_f32 v137, 0x3727c5ac, v137
    v_rsq_f32 v8, v137
    s_nop 0
    v_mul_f32 v8, 0x3fb8aa3b, v8
    v_mul_f32 v9, -v136, v8
    s_waitcnt vmcnt(4)
    s_waitcnt lgkmcnt(12)
    v_mfma_f32_16x16x32_bf16 v[200:203], v[172:175], v[56:59], v[200:203]
    v_mfma_f32_16x16x32_bf16 v[204:207], v[172:175], v[60:63], v[204:207]
    ds_read_b64_tr_b16 v[144:145], v7 offset:43008
    ds_read_b64_tr_b16 v[146:147], v7 offset:46592
    s_waitcnt lgkmcnt(12)
    v_mfma_f32_16x16x32_bf16 v[208:211], v[176:179], v[56:59], v[208:211]
    v_mfma_f32_16x16x32_bf16 v[212:215], v[176:179], v[60:63], v[212:215]
    ds_read_b64_tr_b16 v[148:149], v7 offset:43040
    ds_read_b64_tr_b16 v[150:151], v7 offset:46624
    s_waitcnt lgkmcnt(12)
    v_mfma_f32_16x16x32_bf16 v[216:219], v[180:183], v[56:59], v[216:219]
    v_mfma_f32_16x16x32_bf16 v[220:223], v[180:183], v[60:63], v[220:223]
    ds_read_b64_tr_b16 v[152:153], v7 offset:43072
    ds_read_b64_tr_b16 v[154:155], v7 offset:46656
    s_waitcnt lgkmcnt(12)
    v_mfma_f32_16x16x32_bf16 v[224:227], v[184:187], v[56:59], v[224:227]
    v_mfma_f32_16x16x32_bf16 v[228:231], v[184:187], v[60:63], v[228:231]
    ds_read_b64_tr_b16 v[156:157], v7 offset:43104
    ds_read_b64_tr_b16 v[158:159], v7 offset:46688
    s_waitcnt lgkmcnt(12)
    v_mfma_f32_16x16x32_bf16 v[232:235], v[188:191], v[56:59], v[232:235]
    v_mfma_f32_16x16x32_bf16 v[236:239], v[188:191], v[60:63], v[236:239]
    ds_read_b64_tr_b16 v[160:161], v7 offset:43136
    ds_read_b64_tr_b16 v[162:163], v7 offset:46720
    s_waitcnt lgkmcnt(12)
    v_mfma_f32_16x16x32_bf16 v[240:243], v[192:195], v[56:59], v[240:243]
    v_mfma_f32_16x16x32_bf16 v[244:247], v[192:195], v[60:63], v[244:247]
    ds_read_b64_tr_b16 v[164:165], v7 offset:43168
    ds_read_b64_tr_b16 v[166:167], v7 offset:46752
    s_waitcnt lgkmcnt(12)
    v_mfma_f32_16x16x32_bf16 v[248:251], v[196:199], v[56:59], v[248:251]
    v_mfma_f32_16x16x32_bf16 v[252:255], v[196:199], v[60:63], v[252:255]
    ds_read_b64_tr_b16 v[168:169], v7 offset:43200
    ds_read_b64_tr_b16 v[170:171], v7 offset:46784
    v_pk_add_f32 v[140:141], v[140:141], v[142:143]
    v_mov_b32 v142, v140
    v_mov_b32 v143, v141
    s_nop 0
    v_permlane16_swap_b32 v140, v142
    v_permlane16_swap_b32 v141, v143
    v_pk_add_f32 v[140:141], v[140:141], v[142:143]
    v_mov_b32 v142, v140
    v_mov_b32 v143, v141
    s_nop 0
    v_permlane32_swap_b32 v140, v142
    v_permlane32_swap_b32 v141, v143
    v_pk_add_f32 v[140:141], v[140:141], v[142:143]
    v_mul_f32 v140, 0x3b000000, v140
    v_mul_f32 v141, 0x3b000000, v141
    v_fma_f32 v141, -v140, v140, v141
    v_max_f32 v141, 0, v141
    v_add_f32 v141, 0x3727c5ac, v141
    v_rsq_f32 v10, v141
    s_nop 0
    v_mul_f32 v10, 0x3fb8aa3b, v10
    v_mul_f32 v11, -v140, v10
    s_waitcnt vmcnt(2)
    s_waitcnt lgkmcnt(12)
    v_mfma_f32_16x16x32_bf16 v[200:203], v[144:147], v[64:67], v[200:203]
    v_mfma_f32_16x16x32_bf16 v[204:207], v[144:147], v[68:71], v[204:207]
    ds_read_b64_tr_b16 v[172:173], v7 offset:50176
    ds_read_b64_tr_b16 v[174:175], v7 offset:53760
    s_waitcnt lgkmcnt(12)
    v_mfma_f32_16x16x32_bf16 v[208:211], v[148:151], v[64:67], v[208:211]
    v_mfma_f32_16x16x32_bf16 v[212:215], v[148:151], v[68:71], v[212:215]
    ds_read_b64_tr_b16 v[176:177], v7 offset:50208
    ds_read_b64_tr_b16 v[178:179], v7 offset:53792
    s_waitcnt lgkmcnt(12)
    v_mfma_f32_16x16x32_bf16 v[216:219], v[152:155], v[64:67], v[216:219]
    v_mfma_f32_16x16x32_bf16 v[220:223], v[152:155], v[68:71], v[220:223]
    ds_read_b64_tr_b16 v[180:181], v7 offset:50240
    ds_read_b64_tr_b16 v[182:183], v7 offset:53824
    s_waitcnt lgkmcnt(12)
    v_mfma_f32_16x16x32_bf16 v[224:227], v[156:159], v[64:67], v[224:227]
    v_mfma_f32_16x16x32_bf16 v[228:231], v[156:159], v[68:71], v[228:231]
    ds_read_b64_tr_b16 v[184:185], v7 offset:50272
    ds_read_b64_tr_b16 v[186:187], v7 offset:53856
    s_waitcnt lgkmcnt(12)
    v_mfma_f32_16x16x32_bf16 v[232:235], v[160:163], v[64:67], v[232:235]
    v_mfma_f32_16x16x32_bf16 v[236:239], v[160:163], v[68:71], v[236:239]
    ds_read_b64_tr_b16 v[188:189], v7 offset:50304
    ds_read_b64_tr_b16 v[190:191], v7 offset:53888
    s_waitcnt lgkmcnt(12)
    v_mfma_f32_16x16x32_bf16 v[240:243], v[164:167], v[64:67], v[240:243]
    v_mfma_f32_16x16x32_bf16 v[244:247], v[164:167], v[68:71], v[244:247]
    ds_read_b64_tr_b16 v[192:193], v7 offset:50336
    ds_read_b64_tr_b16 v[194:195], v7 offset:53920
    s_waitcnt lgkmcnt(12)
    v_mfma_f32_16x16x32_bf16 v[248:251], v[168:171], v[64:67], v[248:251]
    v_mfma_f32_16x16x32_bf16 v[252:255], v[168:171], v[68:71], v[252:255]
    ds_read_b64_tr_b16 v[196:197], v7 offset:50368
    ds_read_b64_tr_b16 v[198:199], v7 offset:53952
    s_waitcnt vmcnt(0)
    s_waitcnt lgkmcnt(12)
    v_mfma_f32_16x16x32_bf16 v[200:203], v[172:175], v[72:75], v[200:203]
    v_mfma_f32_16x16x32_bf16 v[204:207], v[172:175], v[76:79], v[204:207]
    s_waitcnt lgkmcnt(10)
    v_mfma_f32_16x16x32_bf16 v[208:211], v[176:179], v[72:75], v[208:211]
    v_mfma_f32_16x16x32_bf16 v[212:215], v[176:179], v[76:79], v[212:215]
    s_waitcnt lgkmcnt(8)
    v_mfma_f32_16x16x32_bf16 v[216:219], v[180:183], v[72:75], v[216:219]
    v_mfma_f32_16x16x32_bf16 v[220:223], v[180:183], v[76:79], v[220:223]
    s_waitcnt lgkmcnt(6)
    v_mfma_f32_16x16x32_bf16 v[224:227], v[184:187], v[72:75], v[224:227]
    v_mfma_f32_16x16x32_bf16 v[228:231], v[184:187], v[76:79], v[228:231]
    s_waitcnt lgkmcnt(4)
    v_mfma_f32_16x16x32_bf16 v[232:235], v[188:191], v[72:75], v[232:235]
    v_mfma_f32_16x16x32_bf16 v[236:239], v[188:191], v[76:79], v[236:239]
    s_waitcnt lgkmcnt(2)
    v_mfma_f32_16x16x32_bf16 v[240:243], v[192:195], v[72:75], v[240:243]
    v_mfma_f32_16x16x32_bf16 v[244:247], v[192:195], v[76:79], v[244:247]
    s_waitcnt lgkmcnt(0)
    v_mfma_f32_16x16x32_bf16 v[248:251], v[196:199], v[72:75], v[248:251]
    v_mfma_f32_16x16x32_bf16 v[252:255], v[196:199], v[76:79], v[252:255]
    s_cmp_eq_u32 s57, 0
    s_cbranch_scc0 L_r0_31
    v_lshrrev_b32 v20, 2, v3
    v_lshl_add_u32 v21, v4, 2, v20
    v_lshlrev_b32 v21, 7, v21
    v_lshrrev_b32 v20, 1, v20
    v_lshl_add_u32 v20, v4, 1, v20
    v_and_b32 v20, 3, v20
    v_and_b32 v22, 3, v3
    v_lshrrev_b32 v23, 1, v22
    v_lshl_add_u32 v21, v23, 4, v21
    v_and_b32 v22, 1, v22
    v_lshl_add_u32 v21, v22, 3, v21
    v_add_u32 v21, s72, v21
    v_xor_b32 v22, 0, v20
    v_lshl_add_u32 v16, v22, 5, v21
    v_xor_b32 v22, 1, v20
    v_lshl_add_u32 v17, v22, 5, v21
    v_xor_b32 v22, 2, v20
    v_lshl_add_u32 v18, v22, 5, v21
    v_xor_b32 v22, 3, v20
    v_lshl_add_u32 v19, v22, 5, v21
    ds_read_b64_tr_b16 a[144:145], v16 offset:0
    ds_read_b64_tr_b16 a[146:147], v16 offset:2048
    ds_read_b64_tr_b16 a[148:149], v17 offset:0
    ds_read_b64_tr_b16 a[150:151], v17 offset:2048
    ds_read_b64_tr_b16 a[152:153], v18 offset:0
    ds_read_b64_tr_b16 a[154:155], v18 offset:2048
    ds_read_b64_tr_b16 a[156:157], v19 offset:0
    ds_read_b64_tr_b16 a[158:159], v19 offset:2048
    s_waitcnt lgkmcnt(6)
    ds_read_b64_tr_b16 a[160:161], v16 offset:4096
    ds_read_b64_tr_b16 a[162:163], v16 offset:6144
    ds_read_b64_tr_b16 a[164:165], v17 offset:4096
    ds_read_b64_tr_b16 a[166:167], v17 offset:6144
    ds_read_b64_tr_b16 a[168:169], v18 offset:4096
    ds_read_b64_tr_b16 a[170:171], v18 offset:6144
    ds_read_b64_tr_b16 a[172:173], v19 offset:4096
    ds_read_b64_tr_b16 a[174:175], v19 offset:6144
    s_waitcnt lgkmcnt(6)
    ds_read_b64_tr_b16 a[176:177], v16 offset:8192
    ds_read_b64_tr_b16 a[178:179], v16 offset:10240
    ds_read_b64_tr_b16 a[180:181], v17 offset:8192
    ds_read_b64_tr_b16 a[182:183], v17 offset:10240
    ds_read_b64_tr_b16 a[184:185], v18 offset:8192
    ds_read_b64_tr_b16 a[186:187], v18 offset:10240
    ds_read_b64_tr_b16 a[188:189], v19 offset:8192
    ds_read_b64_tr_b16 a[190:191], v19 offset:10240
    s_waitcnt lgkmcnt(6)
    s_waitcnt lgkmcnt(0)
    s_add_u32 m0, s72, 0
    s_add_u32 s75, s74, 376832
    buffer_load_dwordx4 v14, s[32:35], s75 offen lds
    s_add_u32 m0, s72, 1024
    s_add_u32 s75, s74, 385024
    buffer_load_dwordx4 v14, s[32:35], s75 offen lds
    s_add_u32 m0, s72, 2048
    s_add_u32 s75, s74, 393216
    buffer_load_dwordx4 v14, s[32:35], s75 offen lds
    s_add_u32 m0, s72, 3072
    s_add_u32 s75, s74, 401408
    buffer_load_dwordx4 v14, s[32:35], s75 offen lds
    s_add_u32 m0, s72, 4096
    s_add_u32 s75, s74, 409600
    buffer_load_dwordx4 v14, s[32:35], s75 offen lds
    s_add_u32 m0, s72, 5120
    s_add_u32 s75, s74, 417792
    buffer_load_dwordx4 v14, s[32:35], s75 offen lds
    s_add_u32 m0, s72, 6144
    s_add_u32 s75, s74, 425984
    buffer_load_dwordx4 v14, s[32:35], s75 offen lds
    s_add_u32 m0, s72, 7168
    s_add_u32 s75, s74, 434176
    buffer_load_dwordx4 v14, s[32:35], s75 offen lds
L_r0_31:
    s_lshl_b32 s61, s53, 3
    s_lshl_b32 s62, s3, 1
    s_add_u32 s61, s61, s62
    s_lshl_b32 s61, s61, 4
    s_add_u32 s61, s61, s54
    s_mul_i32 s61, s61, 3584
    s_mul_i32 s62, s57, 0
    s_add_u32 s61, s61, s62
    s_add_u32 s66, s61, 9437184
    s_add_u32 s67, s66, 57344
    v_pk_fma_f32 v[48:49], v[80:81], v[8:9], v[108:109] op_sel:[0,1,0] op_sel_hi:[1,1,1]
    v_pk_fma_f32 v[54:55], v[82:83], v[8:9], v[110:111] op_sel:[0,1,0] op_sel_hi:[1,1,1]
    v_pk_fma_f32 v[60:61], v[80:81], v[10:11], v[108:109] op_sel:[0,1,0] op_sel_hi:[1,1,1]
    v_pk_fma_f32 v[66:67], v[82:83], v[10:11], v[110:111] op_sel:[0,1,0] op_sel_hi:[1,1,1]
    v_pk_fma_f32 v[48:49], v[200:201], v[8:9], v[48:49] op_sel:[0,0,0] op_sel_hi:[1,0,1]
    v_pk_fma_f32 v[54:55], v[202:203], v[8:9], v[54:55] op_sel:[0,0,0] op_sel_hi:[1,0,1]
    v_pk_fma_f32 v[60:61], v[204:205], v[10:11], v[60:61] op_sel:[0,0,0] op_sel_hi:[1,0,1]
    v_pk_fma_f32 v[66:67], v[206:207], v[10:11], v[66:67] op_sel:[0,0,0] op_sel_hi:[1,0,1]
    v_exp_f32 v50, v48
    v_exp_f32 v51, v49
    v_exp_f32 v56, v54
    v_exp_f32 v57, v55
    v_exp_f32 v62, v60
    v_exp_f32 v63, v61
    v_exp_f32 v68, v66
    v_exp_f32 v69, v67
    v_pk_add_f32 v[52:53], v[50:51], s[76:77]
    v_pk_add_f32 v[58:59], v[56:57], s[76:77]
    v_pk_add_f32 v[64:65], v[62:63], s[76:77]
    v_pk_add_f32 v[70:71], v[68:69], s[76:77]
    v_pk_fma_f32 v[50:51], v[50:51], v[52:53], s[76:77]
    v_pk_fma_f32 v[56:57], v[56:57], v[58:59], s[76:77]
    v_pk_fma_f32 v[62:63], v[62:63], v[64:65], s[76:77]
    v_pk_fma_f32 v[68:69], v[68:69], v[70:71], s[76:77]
    v_rcp_f32 v50, v50
    v_rcp_f32 v51, v51
    v_rcp_f32 v56, v56
    v_rcp_f32 v57, v57
    v_rcp_f32 v62, v62
    v_rcp_f32 v63, v63
    v_rcp_f32 v68, v68
    v_rcp_f32 v69, v69
    v_pk_fma_f32 v[50:51], v[50:51], s[78:79], v[12:13]
    v_pk_fma_f32 v[56:57], v[56:57], s[78:79], v[12:13]
    v_pk_fma_f32 v[62:63], v[62:63], s[78:79], v[12:13]
    v_pk_fma_f32 v[68:69], v[68:69], s[78:79], v[12:13]
    v_pk_mul_f32 v[48:49], v[48:49], v[50:51]
    v_pk_mul_f32 v[54:55], v[54:55], v[56:57]
    v_pk_mul_f32 v[60:61], v[60:61], v[62:63]
    v_pk_mul_f32 v[66:67], v[66:67], v[68:69]
    v_cvt_pk_bf16_f32 v16, v48, v49
    v_cvt_pk_bf16_f32 v17, v54, v55
    v_cvt_pk_bf16_f32 v32, v60, v61
    v_cvt_pk_bf16_f32 v33, v66, v67
    v_pk_fma_f32 v[48:49], v[84:85], v[8:9], v[112:113] op_sel:[0,1,0] op_sel_hi:[1,1,1]
    v_pk_fma_f32 v[54:55], v[86:87], v[8:9], v[114:115] op_sel:[0,1,0] op_sel_hi:[1,1,1]
    v_pk_fma_f32 v[60:61], v[84:85], v[10:11], v[112:113] op_sel:[0,1,0] op_sel_hi:[1,1,1]
    v_pk_fma_f32 v[66:67], v[86:87], v[10:11], v[114:115] op_sel:[0,1,0] op_sel_hi:[1,1,1]
    v_pk_fma_f32 v[48:49], v[208:209], v[8:9], v[48:49] op_sel:[0,0,0] op_sel_hi:[1,0,1]
    v_pk_fma_f32 v[54:55], v[210:211], v[8:9], v[54:55] op_sel:[0,0,0] op_sel_hi:[1,0,1]
    v_pk_fma_f32 v[60:61], v[212:213], v[10:11], v[60:61] op_sel:[0,0,0] op_sel_hi:[1,0,1]
    v_pk_fma_f32 v[66:67], v[214:215], v[10:11], v[66:67] op_sel:[0,0,0] op_sel_hi:[1,0,1]
    v_exp_f32 v50, v48
    v_exp_f32 v51, v49
    v_exp_f32 v56, v54
    v_exp_f32 v57, v55
    v_exp_f32 v62, v60
    v_exp_f32 v63, v61
    v_exp_f32 v68, v66
    v_exp_f32 v69, v67
    v_pk_add_f32 v[52:53], v[50:51], s[76:77]
    v_pk_add_f32 v[58:59], v[56:57], s[76:77]
    v_pk_add_f32 v[64:65], v[62:63], s[76:77]
    v_pk_add_f32 v[70:71], v[68:69], s[76:77]
    v_pk_fma_f32 v[50:51], v[50:51], v[52:53], s[76:77]
    v_pk_fma_f32 v[56:57], v[56:57], v[58:59], s[76:77]
    v_pk_fma_f32 v[62:63], v[62:63], v[64:65], s[76:77]
    v_pk_fma_f32 v[68:69], v[68:69], v[70:71], s[76:77]
    v_rcp_f32 v50, v50
    v_rcp_f32 v51, v51
    v_rcp_f32 v56, v56
    v_rcp_f32 v57, v57
    v_rcp_f32 v62, v62
    v_rcp_f32 v63, v63
    v_rcp_f32 v68, v68
    v_rcp_f32 v69, v69
    v_pk_fma_f32 v[50:51], v[50:51], s[78:79], v[12:13]
    v_pk_fma_f32 v[56:57], v[56:57], s[78:79], v[12:13]
    v_pk_fma_f32 v[62:63], v[62:63], s[78:79], v[12:13]
    v_pk_fma_f32 v[68:69], v[68:69], s[78:79], v[12:13]
    v_pk_mul_f32 v[48:49], v[48:49], v[50:51]
    v_pk_mul_f32 v[54:55], v[54:55], v[56:57]
    v_pk_mul_f32 v[60:61], v[60:61], v[62:63]
    v_pk_mul_f32 v[66:67], v[66:67], v[68:69]
    v_cvt_pk_bf16_f32 v18, v48, v49
    v_cvt_pk_bf16_f32 v19, v54, v55
    v_cvt_pk_bf16_f32 v34, v60, v61
    v_cvt_pk_bf16_f32 v35, v66, v67
    s_cmp_eq_u32 s7, 1
    s_cbranch_scc1 L_fast_32
    buffer_store_dwordx4 v[16:19], v1, s[8:11], s66 offen offset:0 sc1
    buffer_store_dwordx4 v[32:35], v1, s[8:11], s67 offen offset:0 sc1
    s_branch L_done_33
L_fast_32:
    buffer_store_dwordx4 v[16:19], v1, s[8:11], s66 offen offset:0
    buffer_store_dwordx4 v[32:35], v1, s[8:11], s67 offen offset:0
L_done_33:
    v_pk_fma_f32 v[48:49], v[88:89], v[8:9], v[116:117] op_sel:[0,1,0] op_sel_hi:[1,1,1]
    v_pk_fma_f32 v[54:55], v[90:91], v[8:9], v[118:119] op_sel:[0,1,0] op_sel_hi:[1,1,1]
    v_pk_fma_f32 v[60:61], v[88:89], v[10:11], v[116:117] op_sel:[0,1,0] op_sel_hi:[1,1,1]
    v_pk_fma_f32 v[66:67], v[90:91], v[10:11], v[118:119] op_sel:[0,1,0] op_sel_hi:[1,1,1]
    v_pk_fma_f32 v[48:49], v[216:217], v[8:9], v[48:49] op_sel:[0,0,0] op_sel_hi:[1,0,1]
    v_pk_fma_f32 v[54:55], v[218:219], v[8:9], v[54:55] op_sel:[0,0,0] op_sel_hi:[1,0,1]
    v_pk_fma_f32 v[60:61], v[220:221], v[10:11], v[60:61] op_sel:[0,0,0] op_sel_hi:[1,0,1]
    v_pk_fma_f32 v[66:67], v[222:223], v[10:11], v[66:67] op_sel:[0,0,0] op_sel_hi:[1,0,1]
    v_exp_f32 v50, v48
    v_exp_f32 v51, v49
    v_exp_f32 v56, v54
    v_exp_f32 v57, v55
    v_exp_f32 v62, v60
    v_exp_f32 v63, v61
    v_exp_f32 v68, v66
    v_exp_f32 v69, v67
    v_pk_add_f32 v[52:53], v[50:51], s[76:77]
    v_pk_add_f32 v[58:59], v[56:57], s[76:77]
    v_pk_add_f32 v[64:65], v[62:63], s[76:77]
    v_pk_add_f32 v[70:71], v[68:69], s[76:77]
    v_pk_fma_f32 v[50:51], v[50:51], v[52:53], s[76:77]
    v_pk_fma_f32 v[56:57], v[56:57], v[58:59], s[76:77]
    v_pk_fma_f32 v[62:63], v[62:63], v[64:65], s[76:77]
    v_pk_fma_f32 v[68:69], v[68:69], v[70:71], s[76:77]
    v_rcp_f32 v50, v50
    v_rcp_f32 v51, v51
    v_rcp_f32 v56, v56
    v_rcp_f32 v57, v57
    v_rcp_f32 v62, v62
    v_rcp_f32 v63, v63
    v_rcp_f32 v68, v68
    v_rcp_f32 v69, v69
    v_pk_fma_f32 v[50:51], v[50:51], s[78:79], v[12:13]
    v_pk_fma_f32 v[56:57], v[56:57], s[78:79], v[12:13]
    v_pk_fma_f32 v[62:63], v[62:63], s[78:79], v[12:13]
    v_pk_fma_f32 v[68:69], v[68:69], s[78:79], v[12:13]
    v_pk_mul_f32 v[48:49], v[48:49], v[50:51]
    v_pk_mul_f32 v[54:55], v[54:55], v[56:57]
    v_pk_mul_f32 v[60:61], v[60:61], v[62:63]
    v_pk_mul_f32 v[66:67], v[66:67], v[68:69]
    v_cvt_pk_bf16_f32 v20, v48, v49
    v_cvt_pk_bf16_f32 v21, v54, v55
    v_cvt_pk_bf16_f32 v36, v60, v61
    v_cvt_pk_bf16_f32 v37, v66, v67
    v_pk_fma_f32 v[48:49], v[92:93], v[8:9], v[120:121] op_sel:[0,1,0] op_sel_hi:[1,1,1]
    v_pk_fma_f32 v[54:55], v[94:95], v[8:9], v[122:123] op_sel:[0,1,0] op_sel_hi:[1,1,1]
    v_pk_fma_f32 v[60:61], v[92:93], v[10:11], v[120:121] op_sel:[0,1,0] op_sel_hi:[1,1,1]
    v_pk_fma_f32 v[66:67], v[94:95], v[10:11], v[122:123] op_sel:[0,1,0] op_sel_hi:[1,1,1]
    v_pk_fma_f32 v[48:49], v[224:225], v[8:9], v[48:49] op_sel:[0,0,0] op_sel_hi:[1,0,1]
    v_pk_fma_f32 v[54:55], v[226:227], v[8:9], v[54:55] op_sel:[0,0,0] op_sel_hi:[1,0,1]
    v_pk_fma_f32 v[60:61], v[228:229], v[10:11], v[60:61] op_sel:[0,0,0] op_sel_hi:[1,0,1]
    v_pk_fma_f32 v[66:67], v[230:231], v[10:11], v[66:67] op_sel:[0,0,0] op_sel_hi:[1,0,1]
    v_exp_f32 v50, v48
    v_exp_f32 v51, v49
    v_exp_f32 v56, v54
    v_exp_f32 v57, v55
    v_exp_f32 v62, v60
    v_exp_f32 v63, v61
    v_exp_f32 v68, v66
    v_exp_f32 v69, v67
    v_pk_add_f32 v[52:53], v[50:51], s[76:77]
    v_pk_add_f32 v[58:59], v[56:57], s[76:77]
    v_pk_add_f32 v[64:65], v[62:63], s[76:77]
    v_pk_add_f32 v[70:71], v[68:69], s[76:77]
    v_pk_fma_f32 v[50:51], v[50:51], v[52:53], s[76:77]
    v_pk_fma_f32 v[56:57], v[56:57], v[58:59], s[76:77]
    v_pk_fma_f32 v[62:63], v[62:63], v[64:65], s[76:77]
    v_pk_fma_f32 v[68:69], v[68:69], v[70:71], s[76:77]
    v_rcp_f32 v50, v50
    v_rcp_f32 v51, v51
    v_rcp_f32 v56, v56
    v_rcp_f32 v57, v57
    v_rcp_f32 v62, v62
    v_rcp_f32 v63, v63
    v_rcp_f32 v68, v68
    v_rcp_f32 v69, v69
    v_pk_fma_f32 v[50:51], v[50:51], s[78:79], v[12:13]
    v_pk_fma_f32 v[56:57], v[56:57], s[78:79], v[12:13]
    v_pk_fma_f32 v[62:63], v[62:63], s[78:79], v[12:13]
    v_pk_fma_f32 v[68:69], v[68:69], s[78:79], v[12:13]
    v_pk_mul_f32 v[48:49], v[48:49], v[50:51]
    v_pk_mul_f32 v[54:55], v[54:55], v[56:57]
    v_pk_mul_f32 v[60:61], v[60:61], v[62:63]
    v_pk_mul_f32 v[66:67], v[66:67], v[68:69]
    v_cvt_pk_bf16_f32 v22, v48, v49
    v_cvt_pk_bf16_f32 v23, v54, v55
    v_cvt_pk_bf16_f32 v38, v60, v61
    v_cvt_pk_bf16_f32 v39, v66, v67
    s_cmp_eq_u32 s7, 1
    s_cbranch_scc1 L_fast_34
    buffer_store_dwordx4 v[20:23], v1, s[8:11], s66 offen offset:1024 sc1
    buffer_store_dwordx4 v[36:39], v1, s[8:11], s67 offen offset:1024 sc1
    s_branch L_done_35
L_fast_34:
    buffer_store_dwordx4 v[20:23], v1, s[8:11], s66 offen offset:1024
    buffer_store_dwordx4 v[36:39], v1, s[8:11], s67 offen offset:1024
L_done_35:
    v_pk_fma_f32 v[48:49], v[96:97], v[8:9], v[124:125] op_sel:[0,1,0] op_sel_hi:[1,1,1]
    v_pk_fma_f32 v[54:55], v[98:99], v[8:9], v[126:127] op_sel:[0,1,0] op_sel_hi:[1,1,1]
    v_pk_fma_f32 v[60:61], v[96:97], v[10:11], v[124:125] op_sel:[0,1,0] op_sel_hi:[1,1,1]
    v_pk_fma_f32 v[66:67], v[98:99], v[10:11], v[126:127] op_sel:[0,1,0] op_sel_hi:[1,1,1]
    v_pk_fma_f32 v[48:49], v[232:233], v[8:9], v[48:49] op_sel:[0,0,0] op_sel_hi:[1,0,1]
    v_pk_fma_f32 v[54:55], v[234:235], v[8:9], v[54:55] op_sel:[0,0,0] op_sel_hi:[1,0,1]
    v_pk_fma_f32 v[60:61], v[236:237], v[10:11], v[60:61] op_sel:[0,0,0] op_sel_hi:[1,0,1]
    v_pk_fma_f32 v[66:67], v[238:239], v[10:11], v[66:67] op_sel:[0,0,0] op_sel_hi:[1,0,1]
    v_exp_f32 v50, v48
    v_exp_f32 v51, v49
    v_exp_f32 v56, v54
    v_exp_f32 v57, v55
    v_exp_f32 v62, v60
    v_exp_f32 v63, v61
    v_exp_f32 v68, v66
    v_exp_f32 v69, v67
    v_pk_add_f32 v[52:53], v[50:51], s[76:77]
    v_pk_add_f32 v[58:59], v[56:57], s[76:77]
    v_pk_add_f32 v[64:65], v[62:63], s[76:77]
    v_pk_add_f32 v[70:71], v[68:69], s[76:77]
    v_pk_fma_f32 v[50:51], v[50:51], v[52:53], s[76:77]
    v_pk_fma_f32 v[56:57], v[56:57], v[58:59], s[76:77]
    v_pk_fma_f32 v[62:63], v[62:63], v[64:65], s[76:77]
    v_pk_fma_f32 v[68:69], v[68:69], v[70:71], s[76:77]
    v_rcp_f32 v50, v50
    v_rcp_f32 v51, v51
    v_rcp_f32 v56, v56
    v_rcp_f32 v57, v57
    v_rcp_f32 v62, v62
    v_rcp_f32 v63, v63
    v_rcp_f32 v68, v68
    v_rcp_f32 v69, v69
    v_pk_fma_f32 v[50:51], v[50:51], s[78:79], v[12:13]
    v_pk_fma_f32 v[56:57], v[56:57], s[78:79], v[12:13]
    v_pk_fma_f32 v[62:63], v[62:63], s[78:79], v[12:13]
    v_pk_fma_f32 v[68:69], v[68:69], s[78:79], v[12:13]
    v_pk_mul_f32 v[48:49], v[48:49], v[50:51]
    v_pk_mul_f32 v[54:55], v[54:55], v[56:57]
    v_pk_mul_f32 v[60:61], v[60:61], v[62:63]
    v_pk_mul_f32 v[66:67], v[66:67], v[68:69]
    v_cvt_pk_bf16_f32 v24, v48, v49
    v_cvt_pk_bf16_f32 v25, v54, v55
    v_cvt_pk_bf16_f32 v40, v60, v61
    v_cvt_pk_bf16_f32 v41, v66, v67
    v_pk_fma_f32 v[48:49], v[100:101], v[8:9], v[128:129] op_sel:[0,1,0] op_sel_hi:[1,1,1]
    v_pk_fma_f32 v[54:55], v[102:103], v[8:9], v[130:131] op_sel:[0,1,0] op_sel_hi:[1,1,1]
    v_pk_fma_f32 v[60:61], v[100:101], v[10:11], v[128:129] op_sel:[0,1,0] op_sel_hi:[1,1,1]
    v_pk_fma_f32 v[66:67], v[102:103], v[10:11], v[130:131] op_sel:[0,1,0] op_sel_hi:[1,1,1]
    v_pk_fma_f32 v[48:49], v[240:241], v[8:9], v[48:49] op_sel:[0,0,0] op_sel_hi:[1,0,1]
    v_pk_fma_f32 v[54:55], v[242:243], v[8:9], v[54:55] op_sel:[0,0,0] op_sel_hi:[1,0,1]
    v_pk_fma_f32 v[60:61], v[244:245], v[10:11], v[60:61] op_sel:[0,0,0] op_sel_hi:[1,0,1]
    v_pk_fma_f32 v[66:67], v[246:247], v[10:11], v[66:67] op_sel:[0,0,0] op_sel_hi:[1,0,1]
    v_exp_f32 v50, v48
    v_exp_f32 v51, v49
    v_exp_f32 v56, v54
    v_exp_f32 v57, v55
    v_exp_f32 v62, v60
    v_exp_f32 v63, v61
    v_exp_f32 v68, v66
    v_exp_f32 v69, v67
    v_pk_add_f32 v[52:53], v[50:51], s[76:77]
    v_pk_add_f32 v[58:59], v[56:57], s[76:77]
    v_pk_add_f32 v[64:65], v[62:63], s[76:77]
    v_pk_add_f32 v[70:71], v[68:69], s[76:77]
    v_pk_fma_f32 v[50:51], v[50:51], v[52:53], s[76:77]
    v_pk_fma_f32 v[56:57], v[56:57], v[58:59], s[76:77]
    v_pk_fma_f32 v[62:63], v[62:63], v[64:65], s[76:77]
    v_pk_fma_f32 v[68:69], v[68:69], v[70:71], s[76:77]
    v_rcp_f32 v50, v50
    v_rcp_f32 v51, v51
    v_rcp_f32 v56, v56
    v_rcp_f32 v57, v57
    v_rcp_f32 v62, v62
    v_rcp_f32 v63, v63
    v_rcp_f32 v68, v68
    v_rcp_f32 v69, v69
    v_pk_fma_f32 v[50:51], v[50:51], s[78:79], v[12:13]
    v_pk_fma_f32 v[56:57], v[56:57], s[78:79], v[12:13]
    v_pk_fma_f32 v[62:63], v[62:63], s[78:79], v[12:13]
    v_pk_fma_f32 v[68:69], v[68:69], s[78:79], v[12:13]
    v_pk_mul_f32 v[48:49], v[48:49], v[50:51]
    v_pk_mul_f32 v[54:55], v[54:55], v[56:57]
    v_pk_mul_f32 v[60:61], v[60:61], v[62:63]
    v_pk_mul_f32 v[66:67], v[66:67], v[68:69]
    v_cvt_pk_bf16_f32 v26, v48, v49
    v_cvt_pk_bf16_f32 v27, v54, v55
    v_cvt_pk_bf16_f32 v42, v60, v61
    v_cvt_pk_bf16_f32 v43, v66, v67
    s_cmp_eq_u32 s7, 1
    s_cbranch_scc1 L_fast_36
    buffer_store_dwordx4 v[24:27], v1, s[8:11], s66 offen offset:2048 sc1
    buffer_store_dwordx4 v[40:43], v1, s[8:11], s67 offen offset:2048 sc1
    s_branch L_done_37
L_fast_36:
    buffer_store_dwordx4 v[24:27], v1, s[8:11], s66 offen offset:2048
    buffer_store_dwordx4 v[40:43], v1, s[8:11], s67 offen offset:2048
L_done_37:
    v_pk_fma_f32 v[48:49], v[104:105], v[8:9], v[132:133] op_sel:[0,1,0] op_sel_hi:[1,1,1]
    v_pk_fma_f32 v[54:55], v[106:107], v[8:9], v[134:135] op_sel:[0,1,0] op_sel_hi:[1,1,1]
    v_pk_fma_f32 v[60:61], v[104:105], v[10:11], v[132:133] op_sel:[0,1,0] op_sel_hi:[1,1,1]
    v_pk_fma_f32 v[66:67], v[106:107], v[10:11], v[134:135] op_sel:[0,1,0] op_sel_hi:[1,1,1]
    v_pk_fma_f32 v[48:49], v[248:249], v[8:9], v[48:49] op_sel:[0,0,0] op_sel_hi:[1,0,1]
    v_pk_fma_f32 v[54:55], v[250:251], v[8:9], v[54:55] op_sel:[0,0,0] op_sel_hi:[1,0,1]
    v_pk_fma_f32 v[60:61], v[252:253], v[10:11], v[60:61] op_sel:[0,0,0] op_sel_hi:[1,0,1]
    v_pk_fma_f32 v[66:67], v[254:255], v[10:11], v[66:67] op_sel:[0,0,0] op_sel_hi:[1,0,1]
    v_exp_f32 v50, v48
    v_exp_f32 v51, v49
    v_exp_f32 v56, v54
    v_exp_f32 v57, v55
    v_exp_f32 v62, v60
    v_exp_f32 v63, v61
    v_exp_f32 v68, v66
    v_exp_f32 v69, v67
    v_pk_add_f32 v[52:53], v[50:51], s[76:77]
    v_pk_add_f32 v[58:59], v[56:57], s[76:77]
    v_pk_add_f32 v[64:65], v[62:63], s[76:77]
    v_pk_add_f32 v[70:71], v[68:69], s[76:77]
    v_pk_fma_f32 v[50:51], v[50:51], v[52:53], s[76:77]
    v_pk_fma_f32 v[56:57], v[56:57], v[58:59], s[76:77]
    v_pk_fma_f32 v[62:63], v[62:63], v[64:65], s[76:77]
    v_pk_fma_f32 v[68:69], v[68:69], v[70:71], s[76:77]
    v_rcp_f32 v50, v50
    v_rcp_f32 v51, v51
    v_rcp_f32 v56, v56
    v_rcp_f32 v57, v57
    v_rcp_f32 v62, v62
    v_rcp_f32 v63, v63
    v_rcp_f32 v68, v68
    v_rcp_f32 v69, v69
    v_pk_fma_f32 v[50:51], v[50:51], s[78:79], v[12:13]
    v_pk_fma_f32 v[56:57], v[56:57], s[78:79], v[12:13]
    v_pk_fma_f32 v[62:63], v[62:63], s[78:79], v[12:13]
    v_pk_fma_f32 v[68:69], v[68:69], s[78:79], v[12:13]
    v_pk_mul_f32 v[48:49], v[48:49], v[50:51]
    v_pk_mul_f32 v[54:55], v[54:55], v[56:57]
    v_pk_mul_f32 v[60:61], v[60:61], v[62:63]
    v_pk_mul_f32 v[66:67], v[66:67], v[68:69]
    v_cvt_pk_bf16_f32 v28, v48, v49
    v_cvt_pk_bf16_f32 v29, v54, v55
    v_cvt_pk_bf16_f32 v44, v60, v61
    v_cvt_pk_bf16_f32 v45, v66, v67
    v_lshrrev_b32 v5, 1, v4
    v_lshlrev_b32 v5, 8, v5
    v_lshl_add_u32 v5, v3, 4, v5
    v_and_b32 v6, 1, v4
    v_lshl_add_u32 v5, v6, 3, v5
    s_cmp_eq_u32 s7, 1
    s_cbranch_scc1 L_fast_38
    buffer_store_dwordx2 v[28:29], v5, s[8:11], s66 offen offset:3072 sc1
    buffer_store_dwordx2 v[44:45], v5, s[8:11], s67 offen offset:3072 sc1
    s_branch L_done_39
L_fast_38:
    buffer_store_dwordx2 v[28:29], v5, s[8:11], s66 offen offset:3072
    buffer_store_dwordx2 v[44:45], v5, s[8:11], s67 offen offset:3072
L_done_39:
    s_waitcnt vmcnt(0)
    s_mul_i32 s65, s57, 98304
    s_add_u32 s65, s65, 102400
    s_lshl_b32 s60, s2, 7
    s_add_u32 s60, s60, s65
    s_lshl_b32 s62, s3, 5
    s_add_u32 s60, s60, s62
    v_mov_b32 v5, s6
    s_mov_b64 exec, 1
    s_cmp_eq_u32 s7, 1
    s_cbranch_scc1 L_fast_40
    buffer_store_dword v5, off, s[8:11], s60 sc1
    s_branch L_done_41
L_fast_40:
    buffer_store_dword v5, off, s[8:11], s60
L_done_41:
    s_mov_b64 exec, -1
    s_cmp_eq_u32 s57, 0
    s_cbranch_scc0 L_r0_42
    v_lshrrev_b32 v20, 2, v3
    v_lshl_add_u32 v21, v4, 2, v20
    v_lshlrev_b32 v21, 7, v21
    v_lshrrev_b32 v20, 1, v20
    v_lshl_add_u32 v20, v4, 1, v20
    v_and_b32 v20, 3, v20
    v_and_b32 v22, 3, v3
    v_lshrrev_b32 v23, 1, v22
    v_lshl_add_u32 v21, v23, 4, v21
    v_and_b32 v22, 1, v22
    v_lshl_add_u32 v21, v22, 3, v21
    v_add_u32 v21, s72, v21
    v_xor_b32 v22, 0, v20
    v_lshl_add_u32 v16, v22, 5, v21
    v_xor_b32 v22, 1, v20
    v_lshl_add_u32 v17, v22, 5, v21
    v_xor_b32 v22, 2, v20
    v_lshl_add_u32 v18, v22, 5, v21
    v_xor_b32 v22, 3, v20
    v_lshl_add_u32 v19, v22, 5, v21
    ds_read_b64_tr_b16 a[192:193], v16 offset:0
    ds_read_b64_tr_b16 a[194:195], v16 offset:2048
    ds_read_b64_tr_b16 a[196:197], v17 offset:0
    ds_read_b64_tr_b16 a[198:199], v17 offset:2048
    ds_read_b64_tr_b16 a[200:201], v18 offset:0
    ds_read_b64_tr_b16 a[202:203], v18 offset:2048
    ds_read_b64_tr_b16 a[204:205], v19 offset:0
    ds_read_b64_tr_b16 a[206:207], v19 offset:2048
    s_waitcnt lgkmcnt(6)
    ds_read_b64_tr_b16 a[208:209], v16 offset:4096
    ds_read_b64_tr_b16 a[210:211], v16 offset:6144
    ds_read_b64_tr_b16 a[212:213], v17 offset:4096
    ds_read_b64_tr_b16 a[214:215], v17 offset:6144
    ds_read_b64_tr_b16 a[216:217], v18 offset:4096
    ds_read_b64_tr_b16 a[218:219], v18 offset:6144
    ds_read_b64_tr_b16 a[220:221], v19 offset:4096
    ds_read_b64_tr_b16 a[222:223], v19 offset:6144
    s_waitcnt lgkmcnt(6)
    s_waitcnt lgkmcnt(0)
L_r0_42:
    s_barrier
    s_add_u32 s61, s69, s65
    s_lshl_b32 s62, s3, 12
    s_add_u32 s61, s61, s62
    s_lshl_b32 s62, s59, 6
    s_add_u32 s61, s61, s62
    v_lshrrev_b32 v5, 1, v0
    v_lshlrev_b32 v5, 10, v5
    v_and_b32 v6, 1, v0
    v_lshl_add_u32 v5, v6, 5, v5
    s_mov_b32 exec_lo, 0xff
    s_mov_b32 exec_hi, 0
    s_mov_b32 s62, 0
L_poll_43:
    buffer_load_dword v6, v5, s[8:11], s61 offen sc1
    s_add_u32 s62, s62, 1
    s_cmp_gt_u32 s62, s58
    s_cbranch_scc1 L_to_45
    s_waitcnt vmcnt(0)
    v_cmp_ne_u32 vcc, s6, v6
    s_cmp_eq_u64 vcc, 0
    s_cbranch_scc0 L_poll_43
    s_branch L_ok_44
L_to_45:
    s_mov_b32 s58, 0
    s_waitcnt vmcnt(0)
L_ok_44:
    s_mov_b64 exec, -1
    s_lshl_b32 s61, s53, 3
    s_lshl_b32 s62, s59, 2
    s_add_u32 s61, s61, s62
    s_lshl_b32 s61, s61, 4
    s_lshl_b32 s62, s3, 2
    s_add_u32 s61, s61, s62
    s_mul_i32 s61, s61, 3584
    s_mul_i32 s62, s57, 0
    s_add_u32 s61, s61, s62
    s_add_u32 s61, s61, 9437184
    s_add_u32 s62, s3, 0
    s_and_b32 s62, s62, 3
    s_mul_i32 s62, s62, 57344
    s_add_u32 s70, s61, s62
    s_add_u32 s62, s3, 1
    s_and_b32 s62, s62, 3
    s_mul_i32 s62, s62, 57344
    s_add_u32 s71, s61, s62
    s_add_u32 s62, s3, 2
    s_and_b32 s62, s62, 3
    s_mul_i32 s62, s62, 57344
    s_add_u32 s72, s61, s62
    s_add_u32 s62, s3, 3
    s_and_b32 s62, s62, 3
    s_mul_i32 s62, s62, 57344
    s_add_u32 s73, s61, s62
    v_add_u32 v208, 0, v1
    v_add_u32 v209, 3584, v1
    v_add_u32 v210, 7168, v1
    v_add_u32 v211, 10752, v1
    v_lshrrev_b32 v212, 1, v4
    v_mul_u32_u24 v212, 3584, v212
    v_and_b32 v213, 1, v4
    v_lshl_add_u32 v212, v213, 8, v212
    v_lshl_add_u32 v212, v3, 4, v212
    v_add_u32 v213, 7168, v212
    buffer_load_dwordx4 v[16:19], v208, s[8:11], s70 offen offset:0 sc1
    buffer_load_dwordx4 v[20:23], v208, s[8:11], s71 offen offset:0 sc1
    buffer_load_dwordx4 v[24:27], v208, s[8:11], s72 offen offset:0 sc1
    buffer_load_dwordx4 v[28:31], v208, s[8:11], s73 offen offset:0 sc1
    buffer_load_dwordx4 v[32:35], v208, s[8:11], s70 offen offset:1024 sc1
    buffer_load_dwordx4 v[36:39], v208, s[8:11], s71 offen offset:1024 sc1
    buffer_load_dwordx4 v[40:43], v208, s[8:11], s72 offen offset:1024 sc1
    buffer_load_dwordx4 v[44:47], v208, s[8:11], s73 offen offset:1024 sc1
    s_waitcnt vmcnt(4)
    v_mfma_f32_16x16x32_bf16 v[144:147], a[0:3], v[16:19], 0
    v_mfma_f32_16x16x32_bf16 v[148:151], a[4:7], v[16:19], 0
    buffer_load_dwordx4 v[48:51], v208, s[8:11], s70 offen offset:2048 sc1
    v_mfma_f32_16x16x32_bf16 v[152:155], a[8:11], v[16:19], 0
    v_mfma_f32_16x16x32_bf16 v[156:159], a[12:15], v[16:19], 0
    buffer_load_dwordx4 v[52:55], v208, s[8:11], s71 offen offset:2048 sc1
    v_mfma_f32_16x16x32_bf16 v[160:163], a[0:3], v[20:23], 0
    v_mfma_f32_16x16x32_bf16 v[164:167], a[4:7], v[20:23], 0
    buffer_load_dwordx4 v[56:59], v208, s[8:11], s72 offen offset:2048 sc1
    v_mfma_f32_16x16x32_bf16 v[168:171], a[8:11], v[20:23], 0
    v_mfma_f32_16x16x32_bf16 v[172:175], a[12:15], v[20:23], 0
    buffer_load_dwordx4 v[60:63], v208, s[8:11], s73 offen offset:2048 sc1
    v_mfma_f32_16x16x32_bf16 v[176:179], a[0:3], v[24:27], 0
    v_mfma_f32_16x16x32_bf16 v[180:183], a[4:7], v[24:27], 0
    buffer_load_dwordx4 v[64:67], v212, s[8:11], s70 offen offset:3072 sc1
    v_mfma_f32_16x16x32_bf16 v[184:187], a[8:11], v[24:27], 0
    v_mfma_f32_16x16x32_bf16 v[188:191], a[12:15], v[24:27], 0
    buffer_load_dwordx4 v[68:71], v212, s[8:11], s71 offen offset:3072 sc1
    v_mfma_f32_16x16x32_bf16 v[192:195], a[0:3], v[28:31], 0
    v_mfma_f32_16x16x32_bf16 v[196:199], a[4:7], v[28:31], 0
    buffer_load_dwordx4 v[72:75], v212, s[8:11], s72 offen offset:3072 sc1
    v_mfma_f32_16x16x32_bf16 v[200:203], a[8:11], v[28:31], 0
    v_mfma_f32_16x16x32_bf16 v[204:207], a[12:15], v[28:31], 0
    buffer_load_dwordx4 v[76:79], v212, s[8:11], s73 offen offset:3072 sc1
    s_waitcnt vmcnt(8)
    v_mfma_f32_16x16x32_bf16 v[144:147], a[16:19], v[32:35], v[144:147]
    v_mfma_f32_16x16x32_bf16 v[148:151], a[20:23], v[32:35], v[148:151]
    buffer_load_dwordx4 v[80:83], v209, s[8:11], s70 offen offset:0 sc1
    v_mfma_f32_16x16x32_bf16 v[152:155], a[24:27], v[32:35], v[152:155]
    v_mfma_f32_16x16x32_bf16 v[156:159], a[28:31], v[32:35], v[156:159]
    buffer_load_dwordx4 v[84:87], v209, s[8:11], s71 offen offset:0 sc1
    v_mfma_f32_16x16x32_bf16 v[160:163], a[16:19], v[36:39], v[160:163]
    v_mfma_f32_16x16x32_bf16 v[164:167], a[20:23], v[36:39], v[164:167]
    buffer_load_dwordx4 v[88:91], v209, s[8:11], s72 offen offset:0 sc1
    v_mfma_f32_16x16x32_bf16 v[168:171], a[24:27], v[36:39], v[168:171]
    v_mfma_f32_16x16x32_bf16 v[172:175], a[28:31], v[36:39], v[172:175]
    buffer_load_dwordx4 v[92:95], v209, s[8:11], s73 offen offset:0 sc1
    v_mfma_f32_16x16x32_bf16 v[176:179], a[16:19], v[40:43], v[176:179]
    v_mfma_f32_16x16x32_bf16 v[180:183], a[20:23], v[40:43], v[180:183]
    buffer_load_dwordx4 v[96:99], v209, s[8:11], s70 offen offset:1024 sc1
    v_mfma_f32_16x16x32_bf16 v[184:187], a[24:27], v[40:43], v[184:187]
    v_mfma_f32_16x16x32_bf16 v[188:191], a[28:31], v[40:43], v[188:191]
    buffer_load_dwordx4 v[100:103], v209, s[8:11], s71 offen offset:1024 sc1
    v_mfma_f32_16x16x32_bf16 v[192:195], a[16:19], v[44:47], v[192:195]
    v_mfma_f32_16x16x32_bf16 v[196:199], a[20:23], v[44:47], v[196:199]
    buffer_load_dwordx4 v[104:107], v209, s[8:11], s72 offen offset:1024 sc1
    v_mfma_f32_16x16x32_bf16 v[200:203], a[24:27], v[44:47], v[200:203]
    v_mfma_f32_16x16x32_bf16 v[204:207], a[28:31], v[44:47], v[204:207]
    buffer_load_dwordx4 v[108:111], v209, s[8:11], s73 offen offset:1024 sc1
    s_waitcnt vmcnt(12)
    v_mfma_f32_16x16x32_bf16 v[144:147], a[32:35], v[48:51], v[144:147]
    v_mfma_f32_16x16x32_bf16 v[148:151], a[36:39], v[48:51], v[148:151]
    v_mfma_f32_16x16x32_bf16 v[152:155], a[40:43], v[48:51], v[152:155]
    v_mfma_f32_16x16x32_bf16 v[156:159], a[44:47], v[48:51], v[156:159]
    buffer_load_dwordx4 v[112:115], v209, s[8:11], s70 offen offset:2048 sc1
    v_mfma_f32_16x16x32_bf16 v[160:163], a[32:35], v[52:55], v[160:163]
    v_mfma_f32_16x16x32_bf16 v[164:167], a[36:39], v[52:55], v[164:167]
    v_mfma_f32_16x16x32_bf16 v[168:171], a[40:43], v[52:55], v[168:171]
    v_mfma_f32_16x16x32_bf16 v[172:175], a[44:47], v[52:55], v[172:175]
    buffer_load_dwordx4 v[116:119], v209, s[8:11], s71 offen offset:2048 sc1
    v_mfma_f32_16x16x32_bf16 v[176:179], a[32:35], v[56:59], v[176:179]
    v_mfma_f32_16x16x32_bf16 v[180:183], a[36:39], v[56:59], v[180:183]
    v_mfma_f32_16x16x32_bf16 v[184:187], a[40:43], v[56:59], v[184:187]
    v_mfma_f32_16x16x32_bf16 v[188:191], a[44:47], v[56:59], v[188:191]
    buffer_load_dwordx4 v[120:123], v209, s[8:11], s72 offen offset:2048 sc1
    v_mfma_f32_16x16x32_bf16 v[192:195], a[32:35], v[60:63], v[192:195]
    v_mfma_f32_16x16x32_bf16 v[196:199], a[36:39], v[60:63], v[196:199]
    v_mfma_f32_16x16x32_bf16 v[200:203], a[40:43], v[60:63], v[200:203]
    v_mfma_f32_16x16x32_bf16 v[204:207], a[44:47], v[60:63], v[204:207]
    buffer_load_dwordx4 v[124:127], v209, s[8:11], s73 offen offset:2048 sc1
    s_waitcnt vmcnt(12)
    v_mfma_f32_16x16x32_bf16 v[144:147], a[48:51], v[64:67], v[144:147]
    v_mfma_f32_16x16x32_bf16 v[148:151], a[52:55], v[64:67], v[148:151]
    v_mfma_f32_16x16x32_bf16 v[152:155], a[56:59], v[64:67], v[152:155]
    v_mfma_f32_16x16x32_bf16 v[156:159], a[60:63], v[64:67], v[156:159]
    buffer_load_dwordx4 v[128:131], v210, s[8:11], s70 offen offset:0 sc1
    v_mfma_f32_16x16x32_bf16 v[160:163], a[48:51], v[68:71], v[160:163]
    v_mfma_f32_16x16x32_bf16 v[164:167], a[52:55], v[68:71], v[164:167]
    v_mfma_f32_16x16x32_bf16 v[168:171], a[56:59], v[68:71], v[168:171]
    v_mfma_f32_16x16x32_bf16 v[172:175], a[60:63], v[68:71], v[172:175]
    buffer_load_dwordx4 v[132:135], v210, s[8:11], s71 offen offset:0 sc1
    v_mfma_f32_16x16x32_bf16 v[176:179], a[48:51], v[72:75], v[176:179]
    v_mfma_f32_16x16x32_bf16 v[180:183], a[52:55], v[72:75], v[180:183]
    v_mfma_f32_16x16x32_bf16 v[184:187], a[56:59], v[72:75], v[184:187]
    v_mfma_f32_16x16x32_bf16 v[188:191], a[60:63], v[72:75], v[188:191]
    buffer_load_dwordx4 v[136:139], v210, s[8:11], s72 offen offset:0 sc1
    v_mfma_f32_16x16x32_bf16 v[192:195], a[48:51], v[76:79], v[192:195]
    v_mfma_f32_16x16x32_bf16 v[196:199], a[52:55], v[76:79], v[196:199]
    v_mfma_f32_16x16x32_bf16 v[200:203], a[56:59], v[76:79], v[200:203]
    v_mfma_f32_16x16x32_bf16 v[204:207], a[60:63], v[76:79], v[204:207]
    buffer_load_dwordx4 v[140:143], v210, s[8:11], s73 offen offset:0 sc1
    s_waitcnt vmcnt(12)
    v_mfma_f32_16x16x32_bf16 v[144:147], a[64:67], v[80:83], v[144:147]
    v_mfma_f32_16x16x32_bf16 v[148:151], a[68:71], v[80:83], v[148:151]
    v_mfma_f32_16x16x32_bf16 v[152:155], a[72:75], v[80:83], v[152:155]
    v_mfma_f32_16x16x32_bf16 v[156:159], a[76:79], v[80:83], v[156:159]
    buffer_load_dwordx4 v[16:19], v210, s[8:11], s70 offen offset:1024 sc1
    v_mfma_f32_16x16x32_bf16 v[160:163], a[64:67], v[84:87], v[160:163]
    v_mfma_f32_16x16x32_bf16 v[164:167], a[68:71], v[84:87], v[164:167]
    v_mfma_f32_16x16x32_bf16 v[168:171], a[72:75], v[84:87], v[168:171]
    v_mfma_f32_16x16x32_bf16 v[172:175], a[76:79], v[84:87], v[172:175]
    buffer_load_dwordx4 v[20:23], v210, s[8:11], s71 offen offset:1024 sc1
    v_mfma_f32_16x16x32_bf16 v[176:179], a[64:67], v[88:91], v[176:179]
    v_mfma_f32_16x16x32_bf16 v[180:183], a[68:71], v[88:91], v[180:183]
    v_mfma_f32_16x16x32_bf16 v[184:187], a[72:75], v[88:91], v[184:187]
    v_mfma_f32_16x16x32_bf16 v[188:191], a[76:79], v[88:91], v[188:191]
    buffer_load_dwordx4 v[24:27], v210, s[8:11], s72 offen offset:1024 sc1
    v_mfma_f32_16x16x32_bf16 v[192:195], a[64:67], v[92:95], v[192:195]
    v_mfma_f32_16x16x32_bf16 v[196:199], a[68:71], v[92:95], v[196:199]
    v_mfma_f32_16x16x32_bf16 v[200:203], a[72:75], v[92:95], v[200:203]
    v_mfma_f32_16x16x32_bf16 v[204:207], a[76:79], v[92:95], v[204:207]
    buffer_load_dwordx4 v[28:31], v210, s[8:11], s73 offen offset:1024 sc1
    s_waitcnt vmcnt(12)
    v_mfma_f32_16x16x32_bf16 v[144:147], a[80:83], v[96:99], v[144:147]
    v_mfma_f32_16x16x32_bf16 v[148:151], a[84:87], v[96:99], v[148:151]
    v_mfma_f32_16x16x32_bf16 v[152:155], a[88:91], v[96:99], v[152:155]
    v_mfma_f32_16x16x32_bf16 v[156:159], a[92:95], v[96:99], v[156:159]
    buffer_load_dwordx4 v[32:35], v210, s[8:11], s70 offen offset:2048 sc1
    v_mfma_f32_16x16x32_bf16 v[160:163], a[80:83], v[100:103], v[160:163]
    v_mfma_f32_16x16x32_bf16 v[164:167], a[84:87], v[100:103], v[164:167]
    v_mfma_f32_16x16x32_bf16 v[168:171], a[88:91], v[100:103], v[168:171]
    v_mfma_f32_16x16x32_bf16 v[172:175], a[92:95], v[100:103], v[172:175]
    buffer_load_dwordx4 v[36:39], v210, s[8:11], s71 offen offset:2048 sc1
    v_mfma_f32_16x16x32_bf16 v[176:179], a[80:83], v[104:107], v[176:179]
    v_mfma_f32_16x16x32_bf16 v[180:183], a[84:87], v[104:107], v[180:183]
    v_mfma_f32_16x16x32_bf16 v[184:187], a[88:91], v[104:107], v[184:187]
    v_mfma_f32_16x16x32_bf16 v[188:191], a[92:95], v[104:107], v[188:191]
    buffer_load_dwordx4 v[40:43], v210, s[8:11], s72 offen offset:2048 sc1
    v_mfma_f32_16x16x32_bf16 v[192:195], a[80:83], v[108:111], v[192:195]
    v_mfma_f32_16x16x32_bf16 v[196:199], a[84:87], v[108:111], v[196:199]
    v_mfma_f32_16x16x32_bf16 v[200:203], a[88:91], v[108:111], v[200:203]
    v_mfma_f32_16x16x32_bf16 v[204:207], a[92:95], v[108:111], v[204:207]
    buffer_load_dwordx4 v[44:47], v210, s[8:11], s73 offen offset:2048 sc1
    s_waitcnt vmcnt(12)
    v_mfma_f32_16x16x32_bf16 v[144:147], a[96:99], v[112:115], v[144:147]
    v_mfma_f32_16x16x32_bf16 v[148:151], a[100:103], v[112:115], v[148:151]
    v_mfma_f32_16x16x32_bf16 v[152:155], a[104:107], v[112:115], v[152:155]
    v_mfma_f32_16x16x32_bf16 v[156:159], a[108:111], v[112:115], v[156:159]
    buffer_load_dwordx4 v[48:51], v213, s[8:11], s70 offen offset:3072 sc1
    v_mfma_f32_16x16x32_bf16 v[160:163], a[96:99], v[116:119], v[160:163]
    v_mfma_f32_16x16x32_bf16 v[164:167], a[100:103], v[116:119], v[164:167]
    v_mfma_f32_16x16x32_bf16 v[168:171], a[104:107], v[116:119], v[168:171]
    v_mfma_f32_16x16x32_bf16 v[172:175], a[108:111], v[116:119], v[172:175]
    buffer_load_dwordx4 v[52:55], v213, s[8:11], s71 offen offset:3072 sc1
    v_mfma_f32_16x16x32_bf16 v[176:179], a[96:99], v[120:123], v[176:179]
    v_mfma_f32_16x16x32_bf16 v[180:183], a[100:103], v[120:123], v[180:183]
    v_mfma_f32_16x16x32_bf16 v[184:187], a[104:107], v[120:123], v[184:187]
    v_mfma_f32_16x16x32_bf16 v[188:191], a[108:111], v[120:123], v[188:191]
    buffer_load_dwordx4 v[56:59], v213, s[8:11], s72 offen offset:3072 sc1
    v_mfma_f32_16x16x32_bf16 v[192:195], a[96:99], v[124:127], v[192:195]
    v_mfma_f32_16x16x32_bf16 v[196:199], a[100:103], v[124:127], v[196:199]
    v_mfma_f32_16x16x32_bf16 v[200:203], a[104:107], v[124:127], v[200:203]
    v_mfma_f32_16x16x32_bf16 v[204:207], a[108:111], v[124:127], v[204:207]
    buffer_load_dwordx4 v[60:63], v213, s[8:11], s73 offen offset:3072 sc1
    s_waitcnt vmcnt(12)
    v_mfma_f32_16x16x32_bf16 v[144:147], a[112:115], v[128:131], v[144:147]
    v_mfma_f32_16x16x32_bf16 v[148:151], a[116:119], v[128:131], v[148:151]
    v_mfma_f32_16x16x32_bf16 v[152:155], a[120:123], v[128:131], v[152:155]
    v_mfma_f32_16x16x32_bf16 v[156:159], a[124:127], v[128:131], v[156:159]
    buffer_load_dwordx4 v[64:67], v211, s[8:11], s70 offen offset:0 sc1
    v_mfma_f32_16x16x32_bf16 v[160:163], a[112:115], v[132:135], v[160:163]
    v_mfma_f32_16x16x32_bf16 v[164:167], a[116:119], v[132:135], v[164:167]
    v_mfma_f32_16x16x32_bf16 v[168:171], a[120:123], v[132:135], v[168:171]
    v_mfma_f32_16x16x32_bf16 v[172:175], a[124:127], v[132:135], v[172:175]
    buffer_load_dwordx4 v[68:71], v211, s[8:11], s71 offen offset:0 sc1
    v_mfma_f32_16x16x32_bf16 v[176:179], a[112:115], v[136:139], v[176:179]
    v_mfma_f32_16x16x32_bf16 v[180:183], a[116:119], v[136:139], v[180:183]
    v_mfma_f32_16x16x32_bf16 v[184:187], a[120:123], v[136:139], v[184:187]
    v_mfma_f32_16x16x32_bf16 v[188:191], a[124:127], v[136:139], v[188:191]
    buffer_load_dwordx4 v[72:75], v211, s[8:11], s72 offen offset:0 sc1
    v_mfma_f32_16x16x32_bf16 v[192:195], a[112:115], v[140:143], v[192:195]
    v_mfma_f32_16x16x32_bf16 v[196:199], a[116:119], v[140:143], v[196:199]
    v_mfma_f32_16x16x32_bf16 v[200:203], a[120:123], v[140:143], v[200:203]
    v_mfma_f32_16x16x32_bf16 v[204:207], a[124:127], v[140:143], v[204:207]
    buffer_load_dwordx4 v[76:79], v211, s[8:11], s73 offen offset:0 sc1
    s_waitcnt vmcnt(12)
    v_mfma_f32_16x16x32_bf16 v[144:147], a[128:131], v[16:19], v[144:147]
    v_mfma_f32_16x16x32_bf16 v[148:151], a[132:135], v[16:19], v[148:151]
    v_mfma_f32_16x16x32_bf16 v[152:155], a[136:139], v[16:19], v[152:155]
    v_mfma_f32_16x16x32_bf16 v[156:159], a[140:143], v[16:19], v[156:159]
    buffer_load_dwordx4 v[80:83], v211, s[8:11], s70 offen offset:1024 sc1
    v_mfma_f32_16x16x32_bf16 v[160:163], a[128:131], v[20:23], v[160:163]
    v_mfma_f32_16x16x32_bf16 v[164:167], a[132:135], v[20:23], v[164:167]
    v_mfma_f32_16x16x32_bf16 v[168:171], a[136:139], v[20:23], v[168:171]
    v_mfma_f32_16x16x32_bf16 v[172:175], a[140:143], v[20:23], v[172:175]
    buffer_load_dwordx4 v[84:87], v211, s[8:11], s71 offen offset:1024 sc1
    v_mfma_f32_16x16x32_bf16 v[176:179], a[128:131], v[24:27], v[176:179]
    v_mfma_f32_16x16x32_bf16 v[180:183], a[132:135], v[24:27], v[180:183]
    v_mfma_f32_16x16x32_bf16 v[184:187], a[136:139], v[24:27], v[184:187]
    v_mfma_f32_16x16x32_bf16 v[188:191], a[140:143], v[24:27], v[188:191]
    buffer_load_dwordx4 v[88:91], v211, s[8:11], s72 offen offset:1024 sc1
    v_mfma_f32_16x16x32_bf16 v[192:195], a[128:131], v[28:31], v[192:195]
    v_mfma_f32_16x16x32_bf16 v[196:199], a[132:135], v[28:31], v[196:199]
    v_mfma_f32_16x16x32_bf16 v[200:203], a[136:139], v[28:31], v[200:203]
    v_mfma_f32_16x16x32_bf16 v[204:207], a[140:143], v[28:31], v[204:207]
    buffer_load_dwordx4 v[92:95], v211, s[8:11], s73 offen offset:1024 sc1
    s_waitcnt vmcnt(12)
    v_mfma_f32_16x16x32_bf16 v[144:147], a[144:147], v[32:35], v[144:147]
    v_mfma_f32_16x16x32_bf16 v[148:151], a[148:151], v[32:35], v[148:151]
    v_mfma_f32_16x16x32_bf16 v[152:155], a[152:155], v[32:35], v[152:155]
    v_mfma_f32_16x16x32_bf16 v[156:159], a[156:159], v[32:35], v[156:159]
    buffer_load_dwordx4 v[96:99], v211, s[8:11], s70 offen offset:2048 sc1
    v_mfma_f32_16x16x32_bf16 v[160:163], a[144:147], v[36:39], v[160:163]
    v_mfma_f32_16x16x32_bf16 v[164:167], a[148:151], v[36:39], v[164:167]
    v_mfma_f32_16x16x32_bf16 v[168:171], a[152:155], v[36:39], v[168:171]
    v_mfma_f32_16x16x32_bf16 v[172:175], a[156:159], v[36:39], v[172:175]
    buffer_load_dwordx4 v[100:103], v211, s[8:11], s71 offen offset:2048 sc1
    v_mfma_f32_16x16x32_bf16 v[176:179], a[144:147], v[40:43], v[176:179]
    v_mfma_f32_16x16x32_bf16 v[180:183], a[148:151], v[40:43], v[180:183]
    v_mfma_f32_16x16x32_bf16 v[184:187], a[152:155], v[40:43], v[184:187]
    v_mfma_f32_16x16x32_bf16 v[188:191], a[156:159], v[40:43], v[188:191]
    buffer_load_dwordx4 v[104:107], v211, s[8:11], s72 offen offset:2048 sc1
    v_mfma_f32_16x16x32_bf16 v[192:195], a[144:147], v[44:47], v[192:195]
    v_mfma_f32_16x16x32_bf16 v[196:199], a[148:151], v[44:47], v[196:199]
    v_mfma_f32_16x16x32_bf16 v[200:203], a[152:155], v[44:47], v[200:203]
    v_mfma_f32_16x16x32_bf16 v[204:207], a[156:159], v[44:47], v[204:207]
    buffer_load_dwordx4 v[108:111], v211, s[8:11], s73 offen offset:2048 sc1
    s_waitcnt vmcnt(12)
    v_mfma_f32_16x16x32_bf16 v[144:147], a[160:163], v[48:51], v[144:147]
    v_mfma_f32_16x16x32_bf16 v[148:151], a[164:167], v[48:51], v[148:151]
    v_mfma_f32_16x16x32_bf16 v[152:155], a[168:171], v[48:51], v[152:155]
    v_mfma_f32_16x16x32_bf16 v[156:159], a[172:175], v[48:51], v[156:159]
    v_mfma_f32_16x16x32_bf16 v[160:163], a[160:163], v[52:55], v[160:163]
    v_mfma_f32_16x16x32_bf16 v[164:167], a[164:167], v[52:55], v[164:167]
    v_mfma_f32_16x16x32_bf16 v[168:171], a[168:171], v[52:55], v[168:171]
    v_mfma_f32_16x16x32_bf16 v[172:175], a[172:175], v[52:55], v[172:175]
    v_mfma_f32_16x16x32_bf16 v[176:179], a[160:163], v[56:59], v[176:179]
    v_mfma_f32_16x16x32_bf16 v[180:183], a[164:167], v[56:59], v[180:183]
    v_mfma_f32_16x16x32_bf16 v[184:187], a[168:171], v[56:59], v[184:187]
    v_mfma_f32_16x16x32_bf16 v[188:191], a[172:175], v[56:59], v[188:191]
    v_mfma_f32_16x16x32_bf16 v[192:195], a[160:163], v[60:63], v[192:195]
    v_mfma_f32_16x16x32_bf16 v[196:199], a[164:167], v[60:63], v[196:199]
    v_mfma_f32_16x16x32_bf16 v[200:203], a[168:171], v[60:63], v[200:203]
    v_mfma_f32_16x16x32_bf16 v[204:207], a[172:175], v[60:63], v[204:207]
    s_waitcnt vmcnt(8)
    v_mfma_f32_16x16x32_bf16 v[144:147], a[176:179], v[64:67], v[144:147]
    v_mfma_f32_16x16x32_bf16 v[148:151], a[180:183], v[64:67], v[148:151]
    v_mfma_f32_16x16x32_bf16 v[152:155], a[184:187], v[64:67], v[152:155]
    v_mfma_f32_16x16x32_bf16 v[156:159], a[188:191], v[64:67], v[156:159]
    v_mfma_f32_16x16x32_bf16 v[160:163], a[176:179], v[68:71], v[160:163]
    v_mfma_f32_16x16x32_bf16 v[164:167], a[180:183], v[68:71], v[164:167]
    v_mfma_f32_16x16x32_bf16 v[168:171], a[184:187], v[68:71], v[168:171]
    v_mfma_f32_16x16x32_bf16 v[172:175], a[188:191], v[68:71], v[172:175]
    v_mfma_f32_16x16x32_bf16 v[176:179], a[176:179], v[72:75], v[176:179]
    v_mfma_f32_16x16x32_bf16 v[180:183], a[180:183], v[72:75], v[180:183]
    v_mfma_f32_16x16x32_bf16 v[184:187], a[184:187], v[72:75], v[184:187]
    v_mfma_f32_16x16x32_bf16 v[188:191], a[188:191], v[72:75], v[188:191]
    v_mfma_f32_16x16x32_bf16 v[192:195], a[176:179], v[76:79], v[192:195]
    v_mfma_f32_16x16x32_bf16 v[196:199], a[180:183], v[76:79], v[196:199]
    v_mfma_f32_16x16x32_bf16 v[200:203], a[184:187], v[76:79], v[200:203]
    v_mfma_f32_16x16x32_bf16 v[204:207], a[188:191], v[76:79], v[204:207]
    s_waitcnt vmcnt(4)
    v_mfma_f32_16x16x32_bf16 v[144:147], a[192:195], v[80:83], v[144:147]
    v_mfma_f32_16x16x32_bf16 v[148:151], a[196:199], v[80:83], v[148:151]
    v_mfma_f32_16x16x32_bf16 v[152:155], a[200:203], v[80:83], v[152:155]
    v_mfma_f32_16x16x32_bf16 v[156:159], a[204:207], v[80:83], v[156:159]
    v_mfma_f32_16x16x32_bf16 v[160:163], a[192:195], v[84:87], v[160:163]
    v_mfma_f32_16x16x32_bf16 v[164:167], a[196:199], v[84:87], v[164:167]
    v_mfma_f32_16x16x32_bf16 v[168:171], a[200:203], v[84:87], v[168:171]
    v_mfma_f32_16x16x32_bf16 v[172:175], a[204:207], v[84:87], v[172:175]
    v_mfma_f32_16x16x32_bf16 v[176:179], a[192:195], v[88:91], v[176:179]
    v_mfma_f32_16x16x32_bf16 v[180:183], a[196:199], v[88:91], v[180:183]
    v_mfma_f32_16x16x32_bf16 v[184:187], a[200:203], v[88:91], v[184:187]
    v_mfma_f32_16x16x32_bf16 v[188:191], a[204:207], v[88:91], v[188:191]
    v_mfma_f32_16x16x32_bf16 v[192:195], a[192:195], v[92:95], v[192:195]
    v_mfma_f32_16x16x32_bf16 v[196:199], a[196:199], v[92:95], v[196:199]
    v_mfma_f32_16x16x32_bf16 v[200:203], a[200:203], v[92:95], v[200:203]
    v_mfma_f32_16x16x32_bf16 v[204:207], a[204:207], v[92:95], v[204:207]
    s_waitcnt vmcnt(0)
    v_mfma_f32_16x16x32_bf16 v[144:147], a[208:211], v[96:99], v[144:147]
    v_mfma_f32_16x16x32_bf16 v[148:151], a[212:215], v[96:99], v[148:151]
    v_mfma_f32_16x16x32_bf16 v[152:155], a[216:219], v[96:99], v[152:155]
    v_mfma_f32_16x16x32_bf16 v[156:159], a[220:223], v[96:99], v[156:159]
    v_mfma_f32_16x16x32_bf16 v[160:163], a[208:211], v[100:103], v[160:163]
    v_mfma_f32_16x16x32_bf16 v[164:167], a[212:215], v[100:103], v[164:167]
    v_mfma_f32_16x16x32_bf16 v[168:171], a[216:219], v[100:103], v[168:171]
    v_mfma_f32_16x16x32_bf16 v[172:175], a[220:223], v[100:103], v[172:175]
    v_mfma_f32_16x16x32_bf16 v[176:179], a[208:211], v[104:107], v[176:179]
    v_mfma_f32_16x16x32_bf16 v[180:183], a[212:215], v[104:107], v[180:183]
    v_mfma_f32_16x16x32_bf16 v[184:187], a[216:219], v[104:107], v[184:187]
    v_mfma_f32_16x16x32_bf16 v[188:191], a[220:223], v[104:107], v[188:191]
    v_mfma_f32_16x16x32_bf16 v[192:195], a[208:211], v[108:111], v[192:195]
    v_mfma_f32_16x16x32_bf16 v[196:199], a[212:215], v[108:111], v[196:199]
    v_mfma_f32_16x16x32_bf16 v[200:203], a[216:219], v[108:111], v[200:203]
    v_mfma_f32_16x16x32_bf16 v[204:207], a[220:223], v[108:111], v[204:207]
    s_add_u32 s61, s3, 1
    s_and_b32 s61, s61, 3
    s_mul_i32 s61, s61, 12288
    s_add_u32 s61, s61, 114688
    v_add_u32 v5, s61, v1
    s_add_u32 s61, s3, 2
    s_and_b32 s61, s61, 3
    s_mul_i32 s61, s61, 12288
    s_add_u32 s61, s61, 118784
    v_add_u32 v6, s61, v1
    s_add_u32 s61, s3, 3
    s_and_b32 s61, s61, 3
    s_mul_i32 s61, s61, 12288
    s_add_u32 s61, s61, 122880
    v_add_u32 v7, s61, v1
    ds_write_b128 v5, v[160:163] offset:0
    ds_write_b128 v5, v[164:167] offset:1024
    ds_write_b128 v5, v[168:171] offset:2048
    ds_write_b128 v5, v[172:175] offset:3072
    ds_write_b128 v6, v[176:179] offset:0
    ds_write_b128 v6, v[180:183] offset:1024
    ds_write_b128 v6, v[184:187] offset:2048
    ds_write_b128 v6, v[188:191] offset:3072
    ds_write_b128 v7, v[192:195] offset:0
    ds_write_b128 v7, v[196:199] offset:1024
    ds_write_b128 v7, v[200:203] offset:2048
    ds_write_b128 v7, v[204:207] offset:3072
    s_mul_i32 s61, s3, 12288
    s_add_u32 s61, s61, 114688
    v_add_u32 v8, s61, v1
    v_accvgpr_read_b32 v64, a224
    v_accvgpr_read_b32 v65, a225
    v_accvgpr_read_b32 v66, a226
    v_accvgpr_read_b32 v67, a227
    v_accvgpr_read_b32 v68, a228
    v_accvgpr_read_b32 v69, a229
    v_accvgpr_read_b32 v70, a230
    v_accvgpr_read_b32 v71, a231
    v_accvgpr_read_b32 v72, a232
    v_accvgpr_read_b32 v73, a233
    v_accvgpr_read_b32 v74, a234
    v_accvgpr_read_b32 v75, a235
    v_accvgpr_read_b32 v76, a236
    v_accvgpr_read_b32 v77, a237
    v_accvgpr_read_b32 v78, a238
    v_accvgpr_read_b32 v79, a239
    v_pk_add_f32 v[64:65], v[64:65], v[144:145]
    v_pk_add_f32 v[66:67], v[66:67], v[146:147]
    v_pk_add_f32 v[68:69], v[68:69], v[148:149]
    v_pk_add_f32 v[70:71], v[70:71], v[150:151]
    v_pk_add_f32 v[72:73], v[72:73], v[152:153]
    v_pk_add_f32 v[74:75], v[74:75], v[154:155]
    v_pk_add_f32 v[76:77], v[76:77], v[156:157]
    v_pk_add_f32 v[78:79], v[78:79], v[158:159]
    s_waitcnt lgkmcnt(0)
    s_barrier
    ds_read_b128 v[16:19], v8 offset:0
    ds_read_b128 v[20:23], v8 offset:1024
    ds_read_b128 v[24:27], v8 offset:2048
    ds_read_b128 v[28:31], v8 offset:3072
    ds_read_b128 v[32:35], v8 offset:4096
    ds_read_b128 v[36:39], v8 offset:5120
    ds_read_b128 v[40:43], v8 offset:6144
    ds_read_b128 v[44:47], v8 offset:7168
    ds_read_b128 v[48:51], v8 offset:8192
    ds_read_b128 v[52:55], v8 offset:9216
    ds_read_b128 v[56:59], v8 offset:10240
    ds_read_b128 v[60:63], v8 offset:11264
    s_waitcnt lgkmcnt(8)
    v_pk_add_f32 v[64:65], v[64:65], v[16:17]
    v_pk_add_f32 v[66:67], v[66:67], v[18:19]
    v_pk_add_f32 v[68:69], v[68:69], v[20:21]
    v_pk_add_f32 v[70:71], v[70:71], v[22:23]
    v_pk_add_f32 v[72:73], v[72:73], v[24:25]
    v_pk_add_f32 v[74:75], v[74:75], v[26:27]
    v_pk_add_f32 v[76:77], v[76:77], v[28:29]
    v_pk_add_f32 v[78:79], v[78:79], v[30:31]
    s_waitcnt lgkmcnt(4)
    v_pk_add_f32 v[64:65], v[64:65], v[32:33]
    v_pk_add_f32 v[66:67], v[66:67], v[34:35]
    v_pk_add_f32 v[68:69], v[68:69], v[36:37]
    v_pk_add_f32 v[70:71], v[70:71], v[38:39]
    v_pk_add_f32 v[72:73], v[72:73], v[40:41]
    v_pk_add_f32 v[74:75], v[74:75], v[42:43]
    v_pk_add_f32 v[76:77], v[76:77], v[44:45]
    v_pk_add_f32 v[78:79], v[78:79], v[46:47]
    s_waitcnt lgkmcnt(0)
    v_pk_add_f32 v[64:65], v[64:65], v[48:49]
    v_pk_add_f32 v[66:67], v[66:67], v[50:51]
    v_pk_add_f32 v[68:69], v[68:69], v[52:53]
    v_pk_add_f32 v[70:71], v[70:71], v[54:55]
    v_pk_add_f32 v[72:73], v[72:73], v[56:57]
    v_pk_add_f32 v[74:75], v[74:75], v[58:59]
    v_pk_add_f32 v[76:77], v[76:77], v[60:61]
    v_pk_add_f32 v[78:79], v[78:79], v[62:63]
    s_cmp_eq_u32 s57, 1
    s_cbranch_scc1 L_out_46
    v_accvgpr_write_b32 a224, v64
    v_accvgpr_write_b32 a225, v65
    v_accvgpr_write_b32 a226, v66
    v_accvgpr_write_b32 a227, v67
    v_accvgpr_write_b32 a228, v68
    v_accvgpr_write_b32 a229, v69
    v_accvgpr_write_b32 a230, v70
    v_accvgpr_write_b32 a231, v71
    v_accvgpr_write_b32 a232, v72
    v_accvgpr_write_b32 a233, v73
    v_accvgpr_write_b32 a234, v74
    v_accvgpr_write_b32 a235, v75
    v_accvgpr_write_b32 a236, v76
    v_accvgpr_write_b32 a237, v77
    v_accvgpr_write_b32 a238, v78
    v_accvgpr_write_b32 a239, v79
    v_pk_add_f32 v[62:63], v[64:65], v[66:67]
    v_pk_mul_f32 v[64:65], v[64:65], v[64:65]
    v_pk_fma_f32 v[64:65], v[66:67], v[66:67], v[64:65]
    v_pk_add_f32 v[62:63], v[62:63], v[68:69]
    v_pk_fma_f32 v[64:65], v[68:69], v[68:69], v[64:65]
    v_pk_add_f32 v[62:63], v[62:63], v[70:71]
    v_pk_fma_f32 v[64:65], v[70:71], v[70:71], v[64:65]
    v_pk_add_f32 v[62:63], v[62:63], v[72:73]
    v_pk_fma_f32 v[64:65], v[72:73], v[72:73], v[64:65]
    v_pk_add_f32 v[62:63], v[62:63], v[74:75]
    v_pk_fma_f32 v[64:65], v[74:75], v[74:75], v[64:65]
    v_pk_add_f32 v[62:63], v[62:63], v[76:77]
    v_pk_fma_f32 v[64:65], v[76:77], v[76:77], v[64:65]
    v_pk_add_f32 v[62:63], v[62:63], v[78:79]
    v_pk_fma_f32 v[64:65], v[78:79], v[78:79], v[64:65]
    v_add_f32 v60, v62, v63
    v_add_f32 v61, v64, v65
    v_mov_b32 v62, v60
    v_mov_b32 v63, v61
    s_nop 0
    v_permlane16_swap_b32 v60, v62
    v_permlane16_swap_b32 v61, v63
    v_pk_add_f32 v[60:61], v[60:61], v[62:63]
    v_mov_b32 v62, v60
    v_mov_b32 v63, v61
    s_nop 0
    v_permlane32_swap_b32 v60, v62
    v_permlane32_swap_b32 v61, v63
    v_pk_add_f32 v[60:61], v[60:61], v[62:63]
    v_mov_b32 v62, s6
    v_mov_b32 v63, s6
    v_lshlrev_b32 v9, 4, v3
    s_lshl_b32 s66, s55, 13
    s_lshl_b32 s63, s3, 8
    s_add_u32 s66, s66, s63
    s_add_u32 s66, s66, 24248320
    s_lshl_b32 s63, s56, 10
    s_add_u32 s62, s66, s63
    s_cmp_eq_u32 s7, 1
    s_cbranch_scc1 L_fast_47
    buffer_store_dwordx4 v[60:63], v9, s[8:11], s62 offen sc1
    s_branch L_done_48
L_fast_47:
    buffer_store_dwordx4 v[60:63], v9, s[8:11], s62 offen
L_done_48:
    v_lshl_add_u32 v9, v4, 11, v9
    s_mov_b32 s62, 0
L_poll_49:
    buffer_load_dwordx4 v[16:19], v9, s[8:11], s66 offen sc1
    buffer_load_dwordx4 v[20:23], v9, s[8:11], s66 offen offset:1024 sc1
    s_add_u32 s62, s62, 1
    s_cmp_gt_u32 s62, s58
    s_cbranch_scc1 L_to_51
    s_waitcnt vmcnt(0)
    v_xor_b32 v24, s6, v18
    v_xor_b32 v25, s6, v22
    v_or_b32 v24, v24, v25
    v_cmp_ne_u32 vcc, 0, v24
    s_cmp_eq_u64 vcc, 0
    s_cbranch_scc0 L_poll_49
    s_branch L_ok_50
L_to_51:
    s_mov_b32 s58, 0
    s_waitcnt vmcnt(0)
L_ok_50:
    v_mov_b32 v18, v20
    v_mov_b32 v19, v21
    v_pk_add_f32 v[16:17], v[16:17], v[18:19]
    v_mov_b32 v18, v16
    v_mov_b32 v19, v17
    s_nop 0
    v_permlane16_swap_b32 v16, v18
    v_permlane16_swap_b32 v17, v19
    v_pk_add_f32 v[16:17], v[16:17], v[18:19]
    v_mov_b32 v18, v16
    v_mov_b32 v19, v17
    s_nop 0
    v_permlane32_swap_b32 v16, v18
    v_permlane32_swap_b32 v17, v19
    v_pk_add_f32 v[16:17], v[16:17], v[18:19]
    v_mul_f32 v16, 0x3b000000, v16
    v_mul_f32 v17, 0x3b000000, v17
    v_fma_f32 v17, -v16, v16, v17
    v_max_f32 v17, 0, v17
    v_add_f32 v17, 0x3727c5ac, v17
    v_rsq_f32 v14, v17
    s_nop 0
    v_mul_f32 v15, -v16, v14
    v_accvgpr_write_b32 a248, v14
    v_accvgpr_write_b32 a249, v15
    s_mov_b32 s57, 1
    s_nop 1
    s_branch L_round
L_out_46:
    v_cvt_pk_bf16_f32 v16, v64, v65
    v_cvt_pk_bf16_f32 v17, v66, v67
    v_cvt_pk_bf16_f32 v18, v68, v69
    v_cvt_pk_bf16_f32 v19, v70, v71
    v_cvt_pk_bf16_f32 v20, v72, v73
    v_cvt_pk_bf16_f32 v21, v74, v75
    v_cvt_pk_bf16_f32 v22, v76, v77
    v_cvt_pk_bf16_f32 v23, v78, v79
    v_lshlrev_b32 v10, 10, v3
    v_lshl_add_u32 v10, v4, 3, v10
    s_lshl_b32 s61, s55, 16
    s_lshl_b32 s62, s3, 14
    s_add_u32 s61, s61, s62
    s_lshl_b32 s62, s56, 7
    s_add_u32 s61, s61, s62
    buffer_store_dwordx2 v[16:17], v10, s[36:39], s61 offen offset:0
    buffer_store_dwordx2 v[18:19], v10, s[36:39], s61 offen offset:32
    buffer_store_dwordx2 v[20:21], v10, s[36:39], s61 offen offset:64
    buffer_store_dwordx2 v[22:23], v10, s[36:39], s61 offen offset:96
L_fin:
L_end:
    s_endpgm
.section .rodata,"a"
.p2align 6
.amdhsa_kernel interleave_layers__ssm_conv_h3__dense_activation_mish__prompt_kernel
  .amdhsa_next_free_vgpr 512
  .amdhsa_next_free_sgpr 102
  .amdhsa_accum_offset 256
  .amdhsa_group_segment_fixed_size 0
  .amdhsa_kernarg_size 104
  .amdhsa_user_sgpr_count 2
  .amdhsa_user_sgpr_kernarg_segment_ptr 1
  .amdhsa_system_sgpr_workgroup_id_x 1
.end_amdhsa_kernel
```
